```python
import torch

def _softmax(x, axis=-1):
    return torch.softmax(x, dim=axis)
def _gelu(x):
    return torch.nn.functional.gelu(x, approximate="tanh")
def _silu(x):
    return torch.nn.functional.silu(x)
def _sigmoid(x):
    return torch.sigmoid(x)
def _layernorm(x, axis=-1, eps=1e-5):
    m = x.mean(dim=axis, keepdim=True)
    v = x.var(dim=axis, keepdim=True, unbiased=False)
    return (x - m) / torch.sqrt(v + eps)
def _scatter_add(tgt, idx, src, axis=0):
    return tgt.clone().index_add_(axis, idx, src)
def _segment_sum(src, seg, n):
    out = torch.zeros((n,) + src.shape[1:], dtype=src.dtype)
    return out.index_add_(0, seg, src)
def _pad(x, pw):
    flat = tuple(v for pair in reversed(pw) for v in pair)
    return torch.nn.functional.pad(x, flat)

kernel_name = 'gated_mix__sliding_local_dilated__mixer_s_mlp__prompt'

def setup_inputs():

    _w = (lambda a: (lambda t: t.to(torch.bfloat16) if t.is_floating_point() else t)(torch.as_tensor(a)))
    def _A_setup():
        B, S, D = 1, 2048, 640
        return {
            "x": _w((lambda *s: torch.randn(*s, dtype=torch.bfloat16) * 0.05)(B, S, D)),
            "wqkv": _w((lambda *s: torch.randn(*s, dtype=torch.bfloat16) * 3.2)(D, 3 * D)),
            "wo": _w((lambda *s: torch.randn(*s, dtype=torch.bfloat16) * 0.1)(D, D)),
        }
    _A_in = _A_setup()

    def _B_setup():
        B, S, D, F = 1, 2048, 640, 1728
        return {
            "x":  _w((lambda *s: torch.randn(*s, dtype=torch.bfloat16) * 0.05)(B, S, D)),
            "w1": _w((lambda *s: torch.randn(*s, dtype=torch.bfloat16) * 3.2)(D, D) * (D ** -0.5)),
            "w2": _w((lambda *s: torch.randn(*s, dtype=torch.bfloat16) * 3.2)(D, D) * (D ** -0.5)),
            "w3": _w((lambda *s: torch.randn(*s, dtype=torch.bfloat16) * 3.2)(D, F) * (D ** -0.5)),
            "w4": _w((lambda *s: torch.randn(*s, dtype=torch.bfloat16) * 3.2)(F, D) * (F ** -0.5)),
        }
    _B_in = _B_setup()

    return {
        "A_x": _A_in["x"],
        "A_wqkv": _A_in["wqkv"],
        "A_wo": _A_in["wo"],
        "B_x": _B_in["x"],
        "B_w1": _B_in["w1"],
        "B_w2": _B_in["w2"],
        "B_w3": _B_in["w3"],
        "B_w4": _B_in["w4"],
        "gate_w": _w((lambda *s: torch.randn(*s, dtype=torch.bfloat16) * 0.05)(640) * 16.0),
    }

def reference(A_x, A_wqkv, A_wo, B_x, B_w1, B_w2, B_w3, B_w4, gate_w):
    def _A_ref(x, wqkv, wo):
        B, S, D = x.shape
        H = 32; Dh = D // H
        W, dil = 8, 2
        qkv = (lambda x, *d: x.permute(*d))((x @ wqkv).reshape(B, S, 3, H, Dh), 2, 0, 3, 1, 4)
        q, k, v = qkv[0], qkv[1], qkv[2]
        scale = Dh ** -0.5
        pos = torch.arange(S)
        off = torch.arange(W) * dil
        idx = pos[:, None] - off[None, :]
        mask = idx >= 0
        idx_c = torch.where(mask, idx, 0).reshape(-1)
        kg = k[:, :, idx_c, :].reshape(B, H, S, W, Dh)
        vg = v[:, :, idx_c, :].reshape(B, H, S, W, Dh)
        logits = torch.einsum("bhsd,bhswd->bhsw", q, kg) * scale
        logits = torch.where(mask[None, None, :, :], logits, -1e9)
        attn = _softmax(logits, axis=-1)
        o = torch.einsum("bhsw,bhswd->bhsd", attn, vg)
        return (lambda x, *d: x.permute(*d))(o, 0, 2, 1, 3).reshape(B, S, D) @ wo

    def _B_ref(x, w1, w2, w3, w4):
        B, S, D = x.shape
        h = _gelu(_layernorm(x, axis=-1) @ w1)
        c = D // 4
        g0 = _pad(h[:, :, 0*c:1*c], ((0, 0), (1, 0), (0, 0)))[:, :S, :]
        g1 = _pad(h[:, :, 1*c:2*c], ((0, 0), (0, 1), (0, 0)))[:, 1:, :]
        g2 = _pad(h[:, :, 2*c:3*c], ((0, 0), (2, 0), (0, 0)))[:, :S, :]
        g3 = _pad(h[:, :, 3*c:   ], ((0, 0), (0, 2), (0, 0)))[:, 2:, :]
        hs = torch.concatenate([g0, g1, g2, g3], axis=-1) @ w2
        x1 = x + hs
        h2 = _gelu(_layernorm(x1, axis=-1) @ w3) @ w4
        return x1 + h2

    x = A_x
    g = _sigmoid((x * gate_w).sum(-1, keepdims=True))
    a = _A_ref(x, A_wqkv, A_wo)
    b = _B_ref(x, B_w1, B_w2, B_w3, B_w4)
    return g * a + (1 - g) * b
```

```asm
; @launch grid=(256,1,1) block=(512,1,1) lds=163840
.amdgcn_target "amdgcn-amd-amdhsa--gfx950"
.text
.globl gated_mix__sliding_local_dilated__mixer_s_mlp__prompt_kernel
.p2align 8
.type gated_mix__sliding_local_dilated__mixer_s_mlp__prompt_kernel,@function
gated_mix__sliding_local_dilated__mixer_s_mlp__prompt_kernel:
    s_cmp_ge_u32 s2, 256
    s_cbranch_scc1 Lend
    s_load_dwordx16 s[16:31], s[0:1], 0
    s_load_dwordx8 s[32:39], s[0:1], 64
    v_lshrrev_b32 v1, 6, v0
    s_and_b32 s96, s2, 7
    v_readfirstlane_b32 s66, v1
    s_lshr_b32 s97, s2, 3
    v_and_b32 v1, 63, v0
    s_sub_u32 s79, s66, 4
    v_mov_b32 v14, 0
    s_cmp_lg_u32 s66, 2
    s_cbranch_scc1 Lcp_1
    s_getpc_b64 s[4:5]
Lpc0:
    s_lshl_b32 s6, s97, 11
    v_lshl_add_u32 v4, v1, 7, s6
    v_min_u32 v4, Lend-Lpc0, v4
    s_mov_b64 exec, 0xffff
    global_load_dword v15, v4, s[4:5]
    s_mov_b64 exec, -1
Lcp_1:
    s_cmp_lg_u32 s2, 0
    s_cbranch_scc1 Ltg_2
    s_cmp_lg_u32 s66, 3
    s_cbranch_scc1 Ltg_2
    s_memrealtime s[4:5]
    s_waitcnt lgkmcnt(0)
    s_mov_b32 s92, s36
    s_mov_b32 s93, s37
    s_mov_b32 s94, 256
    s_mov_b32 s95, 0x00020000
    s_or_b32 s4, s4, 1
    v_mov_b32 v4, 0
    v_mov_b32 v6, s4
    v_mov_b32 v7, s5
    s_mov_b64 exec, 1
    buffer_store_dwordx2 v[6:7], v4, s[92:95], 0 offen sc1
    s_mov_b64 exec, -1
Ltg_2:
    s_cmp_ge_u32 s66, 4
    s_cbranch_scc1 Lcold_L1
    s_lshr_b32 s5, s96, 1
    s_and_b32 s3, s96, 1
    s_and_b32 s6, s97, 7
    s_lshl_b32 s5, s5, 3
    s_add_u32 s77, s5, s6
    s_lshr_b32 s4, s97, 3
    s_lshl_b32 s3, s3, 2
    s_add_u32 s78, s3, s4
    s_lshl_b32 s64, s77, 6
    s_mul_i32 s65, s78, 80
    s_lshl_b32 s14, s77, 3
    s_add_u32 s14, s14, s78
    s_waitcnt lgkmcnt(0)
    s_add_u32 s48, s38, 8392704
    s_addc_u32 s49, s39, 0
    s_mov_b32 s50, 2621440
    s_mov_b32 s51, 0x00020000
    s_mul_i32 s71, s66, 16
    s_add_u32 s71, s71, s64
    s_lshr_b32 s72, s78, 1
    s_lshl_b32 s72, s72, 2
    s_lshr_b32 s72, 0x0413, s72
    s_and_b32 s72, s72, 15
    s_add_u32 s71, s71, s72
    s_sub_u32 s71, s71, 2
    v_and_b32 v4, 15, v1
    v_add_u32 v4, s71, v4
    v_cmp_gt_u32 vcc, 2048, v4
    v_lshrrev_b32 v5, 4, v4
    v_mul_u32_u24 v5, 20480, v5
    v_and_b32 v4, 15, v4
    v_lshl_add_u32 v5, v4, 4, v5
    s_lshl_b32 s72, s65, 5
    v_add_u32 v5, s72, v5
    v_lshrrev_b32 v6, 4, v1
    v_and_b32 v7, 1, v6
    v_lshrrev_b32 v6, 1, v6
    v_lshl_add_u32 v4, v6, 8, v5
    v_lshl_add_u32 v234, v7, 9, v4
    v_lshl_add_u32 v235, v7, 3, v4
    v_mov_b32 v242, v4
    v_mov_b32 v243, v7
    v_bfrev_b32 v7, 1
    v_cndmask_b32 v234, v7, v234, vcc
    v_cndmask_b32 v235, v7, v235, vcc
    s_mov_b32 s92, s16
    s_mov_b32 s93, s17
    s_mov_b32 s94, 2621440
    s_mov_b32 s95, 0x00020000
    s_mul_i32 s71, s2, 10240
    v_lshlrev_b32 v4, 7, v0
    v_cmp_gt_u32 vcc, 10240, v4
    v_bfrev_b32 v5, 1
    s_nop 0
    v_cndmask_b32 v4, v5, v4, vcc
    buffer_load_dword v15, v4, s[92:95], s71 offen
    s_mov_b32 s92, s24
    s_mov_b32 s93, s25
    s_mov_b32 s94, 819200
    s_mov_b32 s95, 0x00020000
    s_mul_i32 s71, s2, 3200
    v_lshlrev_b32 v4, 7, v0
    v_cmp_gt_u32 vcc, 3200, v4
    v_bfrev_b32 v5, 1
    s_nop 0
    v_cndmask_b32 v4, v5, v4, vcc
    buffer_load_dword v15, v4, s[92:95], s71 offen
    s_lshl_b32 s71, s66, 4
    s_add_u32 s71, s71, s64
    v_and_b32 v4, 15, v1
    v_add_u32 v4, s71, v4
    v_lshrrev_b32 v5, 4, v1
    s_lshl_b32 s72, s65, 1
    v_lshl_add_u32 v5, v5, 3, s72
    s_mov_b32 s73, 1280
    v_mad_u32_u24 v199, v4, s73, v5
    s_lshl_b32 s72, s78, 14
    v_lshl_add_u32 v221, v4, 3, s72
    v_and_b32 v2, 15, v1
    v_lshrrev_b32 v3, 4, v1
    s_mov_b32 s71, s66
    s_mov_b32 s72, 0
    v_bfe_u32 v4, v2, 1, 3
    v_xor_b32 v4, v4, v3
    v_lshlrev_b32 v4, 4, v4
    v_lshl_add_u32 v4, v2, 7, v4
    s_mul_i32 s73, s71, 2048
    v_add_u32 v8, s73, v4
    v_xor_b32 v9, 64, v8
    v_lshrrev_b32 v4, 2, v2
    v_lshl_add_u32 v4, v3, 3, v4
    v_mov_b32 v6, 0
    v_bfe_u32 v5, v4, 3, 1
    v_lshl_or_b32 v6, v5, 0, v6
    v_mul_u32_u24 v4, 192, v4
    v_and_b32 v5, 3, v2
    v_lshl_add_u32 v4, v5, 3, v4
    v_add_u32 v4, 8192, v4
    s_mul_i32 s74, s72, 5
    s_add_u32 s73, s74, 0
    v_xor_b32 v5, s73, v6
    v_lshl_add_u32 v244, v5, 5, v4
    s_add_u32 s73, s74, 1
    v_xor_b32 v5, s73, v6
    v_lshl_add_u32 v245, v5, 5, v4
    s_add_u32 s73, s74, 2
    v_xor_b32 v5, s73, v6
    v_lshl_add_u32 v246, v5, 5, v4
    s_add_u32 s73, s74, 3
    v_xor_b32 v5, s73, v6
    v_lshl_add_u32 v247, v5, 5, v4
    s_add_u32 s73, s74, 4
    v_xor_b32 v5, s73, v6
    v_lshl_add_u32 v248, v5, 5, v4
    s_mul_i32 s73, s66, 2816
    s_add_u32 s73, s73, 102400
    v_mul_u32_u24 v4, 176, v2
    v_lshl_add_u32 v4, v3, 3, v4
    v_add_u32 v12, s73, v4
    v_mov_b32 v16, 0
    v_mov_b32 v17, 0
    v_mov_b32 v18, 0
    v_mov_b32 v19, 0
    v_mov_b32 v20, 0
    v_mov_b32 v21, 0
    v_mov_b32 v22, 0
    v_mov_b32 v23, 0
    v_mov_b32 v24, 0
    v_mov_b32 v25, 0
    v_mov_b32 v26, 0
    v_mov_b32 v27, 0
    v_mov_b32 v28, 0
    v_mov_b32 v29, 0
    v_mov_b32 v30, 0
    v_mov_b32 v31, 0
    v_mov_b32 v32, 0
    v_mov_b32 v33, 0
    v_mov_b32 v34, 0
    v_mov_b32 v35, 0
    v_mov_b32 v84, 0
    v_mov_b32 v85, 0
    v_mov_b32 v86, 0
    v_mov_b32 v87, 0
    v_mov_b32 v88, 0
    v_mov_b32 v89, 0
    v_mov_b32 v90, 0
    v_mov_b32 v91, 0
    v_mov_b32 v92, 0
    v_mov_b32 v93, 0
    v_mov_b32 v94, 0
    v_mov_b32 v95, 0
    v_mov_b32 v96, 0
    v_mov_b32 v97, 0
    v_mov_b32 v98, 0
    v_mov_b32 v99, 0
    v_mov_b32 v100, 0
    v_mov_b32 v101, 0
    v_mov_b32 v102, 0
    v_mov_b32 v103, 0
    v_mov_b32 v104, 0
    v_mov_b32 v105, 0
    v_mov_b32 v106, 0
    v_mov_b32 v107, 0
    v_mov_b32 v108, 0
    v_mov_b32 v109, 0
    v_mov_b32 v110, 0
    v_mov_b32 v111, 0
    v_mov_b32 v112, 0x3f803f80
    v_mov_b32 v113, 0x3f803f80
    v_mov_b32 v114, 0x3f803f80
    v_mov_b32 v115, 0x3f803f80
    s_mov_b32 s69, 0
    s_barrier
    ds_read_b128 v[36:39], v8 offset:0
    ds_read_b64_tr_b16 v[40:41], v244 offset:0
    ds_read_b64_tr_b16 v[42:43], v244 offset:768
    ds_read_b64_tr_b16 v[44:45], v245 offset:0
    ds_read_b64_tr_b16 v[46:47], v245 offset:768
    ds_read_b64_tr_b16 v[48:49], v246 offset:0
    ds_read_b64_tr_b16 v[50:51], v246 offset:768
    ds_read_b64_tr_b16 v[52:53], v247 offset:0
    ds_read_b64_tr_b16 v[54:55], v247 offset:768
    ds_read_b64_tr_b16 v[56:57], v248 offset:0
    ds_read_b64_tr_b16 v[58:59], v248 offset:768
    s_mov_b32 s92, s18
    s_mov_b32 s93, s19
    s_mov_b32 s94, 2457600
    s_mov_b32 s95, 0x00020000
    s_mul_i32 s71, s2, 9600
    v_lshlrev_b32 v4, 7, v0
    v_cmp_gt_u32 vcc, 9600, v4
    v_bfrev_b32 v5, 1
    s_nop 0
    v_cndmask_b32 v4, v5, v4, vcc
    buffer_load_dword v15, v4, s[92:95], s71 offen
    s_mul_i32 s71, s77, 20
    s_mul_i32 s72, s78, 160
    s_mul_i32 s73, s78, 102400
    s_add_u32 s73, s73, 33554432
    s_mov_b32 s92, s26
    s_mov_b32 s93, s27
    s_mov_b32 s94, 819200
    s_mov_b32 s95, 0x00020000
    v_add_u32 v4, 0, v0
    v_mul_u32_u24 v5, 6554, v4
    v_lshrrev_b32 v5, 16, v5
    v_mul_u32_u24 v6, 10, v5
    v_sub_u32 v6, v4, v6
    v_lshlrev_b32 v6, 4, v6
    v_cmp_gt_u32 vcc, 200, v4
    v_add_u32 v5, s71, v5
    v_mul_u32_u24 v7, 1280, v5
    v_add3_u32 v7, v7, v6, s72
    v_bfrev_b32 v4, 1
    v_cndmask_b32 v7, v4, v7, vcc
    buffer_load_dwordx4 v[120:123], v7, s[92:95], 0 offen
    v_bfe_u32 v7, v5, 2, 1
    v_bfe_u32 v128, v5, 3, 1
    v_and_b32 v5, 0xfffffff3, v5
    v_lshl_or_b32 v5, v7, 3, v5
    v_lshl_or_b32 v5, v128, 2, v5
    v_mul_u32_u24 v5, 160, v5
    v_add3_u32 v5, v5, v6, s73
    v_cndmask_b32 v128, v4, v5, vcc
    s_mul_i32 s71, s77, 20
    s_mul_i32 s72, s78, 160
    s_mul_i32 s73, s78, 102400
    s_add_u32 s73, s73, 34603008
    s_mov_b32 s92, s20
    s_mov_b32 s93, s21
    s_mov_b32 s94, 819200
    s_mov_b32 s95, 0x00020000
    v_add_u32 v4, 0, v0
    v_mul_u32_u24 v5, 6554, v4
    v_lshrrev_b32 v5, 16, v5
    v_mul_u32_u24 v6, 10, v5
    v_sub_u32 v6, v4, v6
    v_lshlrev_b32 v6, 4, v6
    v_cmp_gt_u32 vcc, 200, v4
    v_add_u32 v5, s71, v5
    v_mul_u32_u24 v7, 1280, v5
    v_add3_u32 v7, v7, v6, s72
    v_bfrev_b32 v4, 1
    v_cndmask_b32 v7, v4, v7, vcc
    buffer_load_dwordx4 v[124:127], v7, s[92:95], 0 offen
    v_bfe_u32 v7, v5, 2, 1
    v_bfe_u32 v129, v5, 3, 1
    v_and_b32 v5, 0xfffffff3, v5
    v_lshl_or_b32 v5, v7, 3, v5
    v_lshl_or_b32 v5, v129, 2, v5
    v_mul_u32_u24 v5, 160, v5
    v_add3_u32 v5, v5, v6, s73
    v_cndmask_b32 v129, v4, v5, vcc
    s_mov_b32 s70, 9
Lc_3:
    s_waitcnt lgkmcnt(0)
    v_mfma_f32_16x16x32_bf16 v[16:19], v[40:43], v[36:39], v[16:19]
    ds_read_b128 v[60:63], v9 offset:0
    ds_read_b64_tr_b16 v[64:65], v244 offset:6144
    v_mfma_f32_16x16x32_bf16 v[20:23], v[44:47], v[36:39], v[20:23]
    ds_read_b64_tr_b16 v[66:67], v244 offset:6912
    ds_read_b64_tr_b16 v[68:69], v245 offset:6144
    v_mfma_f32_16x16x32_bf16 v[24:27], v[48:51], v[36:39], v[24:27]
    ds_read_b64_tr_b16 v[70:71], v245 offset:6912
    ds_read_b64_tr_b16 v[72:73], v246 offset:6144
    v_mfma_f32_16x16x32_bf16 v[28:31], v[52:55], v[36:39], v[28:31]
    ds_read_b64_tr_b16 v[74:75], v246 offset:6912
    ds_read_b64_tr_b16 v[76:77], v247 offset:6144
    v_mfma_f32_16x16x32_bf16 v[32:35], v[56:59], v[36:39], v[32:35]
    ds_read_b64_tr_b16 v[78:79], v247 offset:6912
    ds_read_b64_tr_b16 v[80:81], v248 offset:6144
    v_mfma_f32_16x16x32_bf16 v[84:87], v[112:115], v[36:39], v[84:87]
    ds_read_b64_tr_b16 v[82:83], v248 offset:6912
    v_mfma_f32_16x16x32_bf16 v[88:91], v[36:39], v[36:39], v[88:91]
    v_mfma_f32_16x16x32_bf16 v[92:95], v[40:43], v[112:115], v[92:95]
    v_mfma_f32_16x16x32_bf16 v[96:99], v[44:47], v[112:115], v[96:99]
    v_mfma_f32_16x16x32_bf16 v[100:103], v[48:51], v[112:115], v[100:103]
    v_mfma_f32_16x16x32_bf16 v[104:107], v[52:55], v[112:115], v[104:107]
    v_mfma_f32_16x16x32_bf16 v[108:111], v[56:59], v[112:115], v[108:111]
    s_add_u32 s69, s69, 20480
    s_cmp_ge_u32 s69, 102400
    s_cselect_b32 s73, 102400, 0
    s_sub_u32 s69, s69, s73
    s_sub_u32 s73, 20480, s73
    v_add_u32 v8, s73, v8
    v_add_u32 v9, s73, v9
    v_add_u32 v244, s73, v244
    v_add_u32 v245, s73, v245
    v_add_u32 v246, s73, v246
    v_add_u32 v247, s73, v247
    v_add_u32 v248, s73, v248
    s_waitcnt lgkmcnt(0)
    v_mfma_f32_16x16x32_bf16 v[16:19], v[64:67], v[60:63], v[16:19]
    ds_read_b128 v[36:39], v8 offset:0
    ds_read_b64_tr_b16 v[40:41], v244 offset:0
    v_mfma_f32_16x16x32_bf16 v[20:23], v[68:71], v[60:63], v[20:23]
    ds_read_b64_tr_b16 v[42:43], v244 offset:768
    ds_read_b64_tr_b16 v[44:45], v245 offset:0
    v_mfma_f32_16x16x32_bf16 v[24:27], v[72:75], v[60:63], v[24:27]
    ds_read_b64_tr_b16 v[46:47], v245 offset:768
    ds_read_b64_tr_b16 v[48:49], v246 offset:0
    v_mfma_f32_16x16x32_bf16 v[28:31], v[76:79], v[60:63], v[28:31]
    ds_read_b64_tr_b16 v[50:51], v246 offset:768
    ds_read_b64_tr_b16 v[52:53], v247 offset:0
    v_mfma_f32_16x16x32_bf16 v[32:35], v[80:83], v[60:63], v[32:35]
    ds_read_b64_tr_b16 v[54:55], v247 offset:768
    ds_read_b64_tr_b16 v[56:57], v248 offset:0
    v_mfma_f32_16x16x32_bf16 v[84:87], v[112:115], v[60:63], v[84:87]
    ds_read_b64_tr_b16 v[58:59], v248 offset:768
    v_mfma_f32_16x16x32_bf16 v[88:91], v[60:63], v[60:63], v[88:91]
    v_mfma_f32_16x16x32_bf16 v[92:95], v[64:67], v[112:115], v[92:95]
    v_mfma_f32_16x16x32_bf16 v[96:99], v[68:71], v[112:115], v[96:99]
    v_mfma_f32_16x16x32_bf16 v[100:103], v[72:75], v[112:115], v[100:103]
    v_mfma_f32_16x16x32_bf16 v[104:107], v[76:79], v[112:115], v[104:107]
    v_mfma_f32_16x16x32_bf16 v[108:111], v[80:83], v[112:115], v[108:111]
    s_cmp_lg_u32 s70, 5
    s_cbranch_scc1 Lmid_4
    s_mov_b32 s92, s28
    s_mov_b32 s93, s29
    s_mov_b32 s94, 2211840
    s_mov_b32 s95, 0x00020000
    s_mul_i32 s71, s2, 8640
    v_lshlrev_b32 v4, 7, v0
    v_cmp_gt_u32 vcc, 8640, v4
    v_bfrev_b32 v5, 1
    s_nop 0
    v_cndmask_b32 v4, v5, v4, vcc
    buffer_load_dword v15, v4, s[92:95], s71 offen
    s_mov_b32 s92, s30
    s_mov_b32 s93, s31
    s_mov_b32 s94, 2211840
    s_mov_b32 s95, 0x00020000
    s_mul_i32 s71, s2, 8640
    v_lshlrev_b32 v4, 7, v0
    v_cmp_gt_u32 vcc, 8640, v4
    v_bfrev_b32 v5, 1
    s_nop 0
    v_cndmask_b32 v4, v5, v4, vcc
    buffer_load_dword v15, v4, s[92:95], s71 offen
Lmid_4:
    s_barrier
    s_sub_u32 s70, s70, 1
    s_cmp_lg_u32 s70, 0
    s_cbranch_scc1 Lc_3
    s_waitcnt lgkmcnt(0)
    v_mfma_f32_16x16x32_bf16 v[16:19], v[40:43], v[36:39], v[16:19]
    ds_read_b128 v[60:63], v9 offset:0
    ds_read_b64_tr_b16 v[64:65], v244 offset:6144
    v_mfma_f32_16x16x32_bf16 v[20:23], v[44:47], v[36:39], v[20:23]
    ds_read_b64_tr_b16 v[66:67], v244 offset:6912
    ds_read_b64_tr_b16 v[68:69], v245 offset:6144
    v_mfma_f32_16x16x32_bf16 v[24:27], v[48:51], v[36:39], v[24:27]
    ds_read_b64_tr_b16 v[70:71], v245 offset:6912
    ds_read_b64_tr_b16 v[72:73], v246 offset:6144
    v_mfma_f32_16x16x32_bf16 v[28:31], v[52:55], v[36:39], v[28:31]
    ds_read_b64_tr_b16 v[74:75], v246 offset:6912
    ds_read_b64_tr_b16 v[76:77], v247 offset:6144
    v_mfma_f32_16x16x32_bf16 v[32:35], v[56:59], v[36:39], v[32:35]
    ds_read_b64_tr_b16 v[78:79], v247 offset:6912
    ds_read_b64_tr_b16 v[80:81], v248 offset:6144
    v_mfma_f32_16x16x32_bf16 v[84:87], v[112:115], v[36:39], v[84:87]
    ds_read_b64_tr_b16 v[82:83], v248 offset:6912
    v_mfma_f32_16x16x32_bf16 v[88:91], v[36:39], v[36:39], v[88:91]
    v_mfma_f32_16x16x32_bf16 v[92:95], v[40:43], v[112:115], v[92:95]
    v_mfma_f32_16x16x32_bf16 v[96:99], v[44:47], v[112:115], v[96:99]
    v_mfma_f32_16x16x32_bf16 v[100:103], v[48:51], v[112:115], v[100:103]
    v_mfma_f32_16x16x32_bf16 v[104:107], v[52:55], v[112:115], v[104:107]
    v_mfma_f32_16x16x32_bf16 v[108:111], v[56:59], v[112:115], v[108:111]
    s_waitcnt lgkmcnt(0)
    v_mfma_f32_16x16x32_bf16 v[16:19], v[64:67], v[60:63], v[16:19]
    v_mfma_f32_16x16x32_bf16 v[20:23], v[68:71], v[60:63], v[20:23]
    v_mfma_f32_16x16x32_bf16 v[24:27], v[72:75], v[60:63], v[24:27]
    v_mfma_f32_16x16x32_bf16 v[28:31], v[76:79], v[60:63], v[28:31]
    v_mfma_f32_16x16x32_bf16 v[32:35], v[80:83], v[60:63], v[32:35]
    v_mfma_f32_16x16x32_bf16 v[84:87], v[112:115], v[60:63], v[84:87]
    v_mfma_f32_16x16x32_bf16 v[88:91], v[60:63], v[60:63], v[88:91]
    v_mfma_f32_16x16x32_bf16 v[92:95], v[64:67], v[112:115], v[92:95]
    v_mfma_f32_16x16x32_bf16 v[96:99], v[68:71], v[112:115], v[96:99]
    v_mfma_f32_16x16x32_bf16 v[100:103], v[72:75], v[112:115], v[100:103]
    v_mfma_f32_16x16x32_bf16 v[104:107], v[76:79], v[112:115], v[104:107]
    v_mfma_f32_16x16x32_bf16 v[108:111], v[80:83], v[112:115], v[108:111]
    s_nop 9
    s_and_b32 s74, s77, 1
    s_lshl_b32 s73, s78, 1
    s_add_u32 s74, s74, s73
    s_lshr_b32 s71, s77, 1
    s_mul_i32 s71, s71, 40
    s_mul_i32 s72, s74, 27
    s_lshr_b32 s72, s72, 1
    s_lshl_b32 s72, s72, 4
    s_mul_i32 s73, s74, 143360
    s_add_u32 s73, s73, 35651584
    s_mov_b32 s92, s28
    s_mov_b32 s93, s29
    s_mov_b32 s94, 2211840
    s_mov_b32 s95, 0x00020000
    v_add_u32 v4, 0, v0
    v_mul_u32_u24 v5, 4682, v4
    v_lshrrev_b32 v5, 16, v5
    v_mul_u32_u24 v6, 14, v5
    v_sub_u32 v6, v4, v6
    v_lshlrev_b32 v6, 4, v6
    v_cmp_gt_u32 vcc, 560, v4
    v_add_u32 v5, s71, v5
    v_mul_u32_u24 v7, 3456, v5
    v_add3_u32 v7, v7, v6, s72
    v_bfrev_b32 v4, 1
    v_cndmask_b32 v7, v4, v7, vcc
    buffer_load_dwordx4 v[150:153], v7, s[92:95], 0 offen
    v_bfe_u32 v7, v5, 2, 1
    v_bfe_u32 v162, v5, 3, 1
    v_and_b32 v5, 0xfffffff3, v5
    v_lshl_or_b32 v5, v7, 3, v5
    v_lshl_or_b32 v5, v162, 2, v5
    v_mul_u32_u24 v5, 224, v5
    v_add3_u32 v5, v5, v6, s73
    v_cndmask_b32 v162, v4, v5, vcc
    v_add_u32 v4, 256, v0
    v_mul_u32_u24 v5, 4682, v4
    v_lshrrev_b32 v5, 16, v5
    v_mul_u32_u24 v6, 14, v5
    v_sub_u32 v6, v4, v6
    v_lshlrev_b32 v6, 4, v6
    v_cmp_gt_u32 vcc, 560, v4
    v_add_u32 v5, s71, v5
    v_mul_u32_u24 v7, 3456, v5
    v_add3_u32 v7, v7, v6, s72
    v_bfrev_b32 v4, 1
    v_cndmask_b32 v7, v4, v7, vcc
    buffer_load_dwordx4 v[154:157], v7, s[92:95], 0 offen
    v_bfe_u32 v7, v5, 2, 1
    v_bfe_u32 v163, v5, 3, 1
    v_and_b32 v5, 0xfffffff3, v5
    v_lshl_or_b32 v5, v7, 3, v5
    v_lshl_or_b32 v5, v163, 2, v5
    v_mul_u32_u24 v5, 224, v5
    v_add3_u32 v5, v5, v6, s73
    v_cndmask_b32 v163, v4, v5, vcc
    v_add_u32 v4, 512, v0
    v_mul_u32_u24 v5, 4682, v4
    v_lshrrev_b32 v5, 16, v5
    v_mul_u32_u24 v6, 14, v5
    v_sub_u32 v6, v4, v6
    v_lshlrev_b32 v6, 4, v6
    v_cmp_gt_u32 vcc, 560, v4
    v_add_u32 v5, s71, v5
    v_mul_u32_u24 v7, 3456, v5
    v_add3_u32 v7, v7, v6, s72
    v_bfrev_b32 v4, 1
    v_cndmask_b32 v7, v4, v7, vcc
    buffer_load_dwordx4 v[158:161], v7, s[92:95], 0 offen
    v_bfe_u32 v7, v5, 2, 1
    v_bfe_u32 v164, v5, 3, 1
    v_and_b32 v5, 0xfffffff3, v5
    v_lshl_or_b32 v5, v7, 3, v5
    v_lshl_or_b32 v5, v164, 2, v5
    v_mul_u32_u24 v5, 224, v5
    v_add3_u32 v5, v5, v6, s73
    v_cndmask_b32 v164, v4, v5, vcc
    s_mov_b32 s92, s38
    s_mov_b32 s93, s39
    s_mov_b32 s94, 41943040
    s_mov_b32 s95, 0x00020000
    s_waitcnt vmcnt(3)
    buffer_store_dwordx4 v[120:123], v128, s[92:95], 0 offen sc1
    buffer_store_dwordx4 v[124:127], v129, s[92:95], 0 offen sc1
    v_and_b32 v4, 3, v2
    v_cmp_eq_u32 s[82:83], 1, v4
    v_cmp_eq_u32 s[84:85], 2, v4
    v_cmp_eq_u32 s[86:87], 3, v4
    v_lshrrev_b32 v5, 2, v2
    v_cmp_eq_u32 s[80:81], v5, v3
    v_mov_b32 v236, 0xbdd2d3e8
    v_mov_b32 v238, 0xc0135761
    v_mov_b32 v240, 1.0
    v_mov_b32 v237, 0xbdd2d3e8
    v_mov_b32 v239, 0xc0135761
    v_mov_b32 v241, 1.0
    v_cndmask_b32 v88, v88, v89, s[82:83]
    v_cndmask_b32 v88, v88, v90, s[84:85]
    v_cndmask_b32 v88, v88, v91, s[86:87]
    v_cndmask_b32 v88, 0, v88, s[80:81]
    v_mov_b32 v36, v88
    v_mov_b32 v37, v88
    s_nop 1
    v_permlane32_swap_b32 v36, v37
    s_nop 0
    v_add_f32 v88, v36, v37
    v_mov_b32 v36, v88
    v_mov_b32 v37, v88
    s_nop 1
    v_permlane16_swap_b32 v36, v37
    s_nop 0
    v_add_f32 v88, v36, v37
    v_mul_f32 v84, 0x3acccccd, v84
    v_mul_f32 v88, 0x3acccccd, v88
    v_fma_f32 v88, -v84, v84, v88
    v_max_f32 v88, 0, v88
    v_cvt_pk_bf16_f32 v85, v84, v84
    v_lshlrev_b32 v85, 16, v85
    v_cvt_pk_bf16_f32 v4, v88, v88
    v_lshlrev_b32 v4, 16, v4
    v_add_f32 v4, 0x3727c5ac, v4
    v_cvt_pk_bf16_f32 v4, v4, v4
    v_lshlrev_b32 v4, 16, v4
    v_sqrt_f32 v4, v4
    s_nop 0
    v_cvt_pk_bf16_f32 v4, v4, v4
    v_lshlrev_b32 v4, 16, v4
    v_rcp_f32 v86, v4
    s_nop 0
    v_mov_b32 v87, v86
    v_fma_f32 v16, -v85, v92, v16
    v_fma_f32 v17, -v85, v93, v17
    v_fma_f32 v18, -v85, v94, v18
    v_fma_f32 v19, -v85, v95, v19
    v_pk_mul_f32 v[16:17], v[16:17], v[86:87]
    v_pk_mul_f32 v[18:19], v[18:19], v[86:87]
    v_cvt_pk_bf16_f32 v40, v16, v17
    v_cvt_pk_bf16_f32 v41, v18, v19
    v_lshlrev_b32 v16, 16, v40
    v_and_b32 v17, 0xffff0000, v40
    v_lshlrev_b32 v18, 16, v41
    v_and_b32 v19, 0xffff0000, v41
    v_pk_mul_f32 v[36:37], v[16:17], v[16:17]
    v_pk_mul_f32 v[38:39], v[18:19], v[18:19]
    v_pk_fma_f32 v[36:37], v[36:37], v[236:237], v[238:239]
    v_pk_fma_f32 v[38:39], v[38:39], v[236:237], v[238:239]
    v_pk_mul_f32 v[36:37], v[36:37], v[16:17]
    v_pk_mul_f32 v[38:39], v[38:39], v[18:19]
    v_exp_f32 v36, v36
    v_exp_f32 v37, v37
    v_exp_f32 v38, v38
    v_exp_f32 v39, v39
    s_nop 0
    v_pk_add_f32 v[36:37], v[36:37], v[240:241]
    v_pk_add_f32 v[38:39], v[38:39], v[240:241]
    v_rcp_f32 v36, v36
    v_rcp_f32 v37, v37
    v_rcp_f32 v38, v38
    v_rcp_f32 v39, v39
    s_nop 0
    v_pk_mul_f32 v[16:17], v[16:17], v[36:37]
    v_pk_mul_f32 v[18:19], v[18:19], v[38:39]
    v_cvt_pk_bf16_f32 v60, v16, v17
    v_cvt_pk_bf16_f32 v61, v18, v19
    v_fma_f32 v20, -v85, v96, v20
    v_fma_f32 v21, -v85, v97, v21
    v_fma_f32 v22, -v85, v98, v22
    v_fma_f32 v23, -v85, v99, v23
    v_pk_mul_f32 v[20:21], v[20:21], v[86:87]
    v_pk_mul_f32 v[22:23], v[22:23], v[86:87]
    v_cvt_pk_bf16_f32 v40, v20, v21
    v_cvt_pk_bf16_f32 v41, v22, v23
    v_lshlrev_b32 v20, 16, v40
    v_and_b32 v21, 0xffff0000, v40
    v_lshlrev_b32 v22, 16, v41
    v_and_b32 v23, 0xffff0000, v41
    v_pk_mul_f32 v[36:37], v[20:21], v[20:21]
    v_pk_mul_f32 v[38:39], v[22:23], v[22:23]
    v_pk_fma_f32 v[36:37], v[36:37], v[236:237], v[238:239]
    v_pk_fma_f32 v[38:39], v[38:39], v[236:237], v[238:239]
    v_pk_mul_f32 v[36:37], v[36:37], v[20:21]
    v_pk_mul_f32 v[38:39], v[38:39], v[22:23]
    v_exp_f32 v36, v36
    v_exp_f32 v37, v37
    v_exp_f32 v38, v38
    v_exp_f32 v39, v39
    s_nop 0
    v_pk_add_f32 v[36:37], v[36:37], v[240:241]
    v_pk_add_f32 v[38:39], v[38:39], v[240:241]
    v_rcp_f32 v36, v36
    v_rcp_f32 v37, v37
    v_rcp_f32 v38, v38
    v_rcp_f32 v39, v39
    s_nop 0
    v_pk_mul_f32 v[20:21], v[20:21], v[36:37]
    v_pk_mul_f32 v[22:23], v[22:23], v[38:39]
    v_cvt_pk_bf16_f32 v62, v20, v21
    v_cvt_pk_bf16_f32 v63, v22, v23
    s_nop 1
    v_permlane16_swap_b32 v60, v62
    v_permlane16_swap_b32 v61, v63
    buffer_store_dwordx4 v[60:63], v234, s[48:51], 0 offen offset:0 sc1
    v_fma_f32 v24, -v85, v100, v24
    v_fma_f32 v25, -v85, v101, v25
    v_fma_f32 v26, -v85, v102, v26
    v_fma_f32 v27, -v85, v103, v27
    v_pk_mul_f32 v[24:25], v[24:25], v[86:87]
    v_pk_mul_f32 v[26:27], v[26:27], v[86:87]
    v_cvt_pk_bf16_f32 v40, v24, v25
    v_cvt_pk_bf16_f32 v41, v26, v27
    v_lshlrev_b32 v24, 16, v40
    v_and_b32 v25, 0xffff0000, v40
    v_lshlrev_b32 v26, 16, v41
    v_and_b32 v27, 0xffff0000, v41
    v_pk_mul_f32 v[36:37], v[24:25], v[24:25]
    v_pk_mul_f32 v[38:39], v[26:27], v[26:27]
    v_pk_fma_f32 v[36:37], v[36:37], v[236:237], v[238:239]
    v_pk_fma_f32 v[38:39], v[38:39], v[236:237], v[238:239]
    v_pk_mul_f32 v[36:37], v[36:37], v[24:25]
    v_pk_mul_f32 v[38:39], v[38:39], v[26:27]
    v_exp_f32 v36, v36
    v_exp_f32 v37, v37
    v_exp_f32 v38, v38
    v_exp_f32 v39, v39
    s_nop 0
    v_pk_add_f32 v[36:37], v[36:37], v[240:241]
    v_pk_add_f32 v[38:39], v[38:39], v[240:241]
    v_rcp_f32 v36, v36
    v_rcp_f32 v37, v37
    v_rcp_f32 v38, v38
    v_rcp_f32 v39, v39
    s_nop 0
    v_pk_mul_f32 v[24:25], v[24:25], v[36:37]
    v_pk_mul_f32 v[26:27], v[26:27], v[38:39]
    v_cvt_pk_bf16_f32 v64, v24, v25
    v_cvt_pk_bf16_f32 v65, v26, v27
    v_fma_f32 v28, -v85, v104, v28
    v_fma_f32 v29, -v85, v105, v29
    v_fma_f32 v30, -v85, v106, v30
    v_fma_f32 v31, -v85, v107, v31
    v_pk_mul_f32 v[28:29], v[28:29], v[86:87]
    v_pk_mul_f32 v[30:31], v[30:31], v[86:87]
    v_cvt_pk_bf16_f32 v40, v28, v29
    v_cvt_pk_bf16_f32 v41, v30, v31
    v_lshlrev_b32 v28, 16, v40
    v_and_b32 v29, 0xffff0000, v40
    v_lshlrev_b32 v30, 16, v41
    v_and_b32 v31, 0xffff0000, v41
    v_pk_mul_f32 v[36:37], v[28:29], v[28:29]
    v_pk_mul_f32 v[38:39], v[30:31], v[30:31]
    v_pk_fma_f32 v[36:37], v[36:37], v[236:237], v[238:239]
    v_pk_fma_f32 v[38:39], v[38:39], v[236:237], v[238:239]
    v_pk_mul_f32 v[36:37], v[36:37], v[28:29]
    v_pk_mul_f32 v[38:39], v[38:39], v[30:31]
    v_exp_f32 v36, v36
    v_exp_f32 v37, v37
    v_exp_f32 v38, v38
    v_exp_f32 v39, v39
    s_nop 0
    v_pk_add_f32 v[36:37], v[36:37], v[240:241]
    v_pk_add_f32 v[38:39], v[38:39], v[240:241]
    v_rcp_f32 v36, v36
    v_rcp_f32 v37, v37
    v_rcp_f32 v38, v38
    v_rcp_f32 v39, v39
    s_nop 0
    v_pk_mul_f32 v[28:29], v[28:29], v[36:37]
    v_pk_mul_f32 v[30:31], v[30:31], v[38:39]
    v_cvt_pk_bf16_f32 v66, v28, v29
    v_cvt_pk_bf16_f32 v67, v30, v31
    s_nop 1
    v_permlane16_swap_b32 v64, v66
    v_permlane16_swap_b32 v65, v67
    buffer_store_dwordx4 v[64:67], v234, s[48:51], 0 offen offset:1024 sc1
    v_fma_f32 v32, -v85, v108, v32
    v_fma_f32 v33, -v85, v109, v33
    v_fma_f32 v34, -v85, v110, v34
    v_fma_f32 v35, -v85, v111, v35
    v_pk_mul_f32 v[32:33], v[32:33], v[86:87]
    v_pk_mul_f32 v[34:35], v[34:35], v[86:87]
    v_cvt_pk_bf16_f32 v40, v32, v33
    v_cvt_pk_bf16_f32 v41, v34, v35
    v_lshlrev_b32 v32, 16, v40
    v_and_b32 v33, 0xffff0000, v40
    v_lshlrev_b32 v34, 16, v41
    v_and_b32 v35, 0xffff0000, v41
    v_pk_mul_f32 v[36:37], v[32:33], v[32:33]
    v_pk_mul_f32 v[38:39], v[34:35], v[34:35]
    v_pk_fma_f32 v[36:37], v[36:37], v[236:237], v[238:239]
    v_pk_fma_f32 v[38:39], v[38:39], v[236:237], v[238:239]
    v_pk_mul_f32 v[36:37], v[36:37], v[32:33]
    v_pk_mul_f32 v[38:39], v[38:39], v[34:35]
    v_exp_f32 v36, v36
    v_exp_f32 v37, v37
    v_exp_f32 v38, v38
    v_exp_f32 v39, v39
    s_nop 0
    v_pk_add_f32 v[36:37], v[36:37], v[240:241]
    v_pk_add_f32 v[38:39], v[38:39], v[240:241]
    v_rcp_f32 v36, v36
    v_rcp_f32 v37, v37
    v_rcp_f32 v38, v38
    v_rcp_f32 v39, v39
    s_nop 0
    v_pk_mul_f32 v[32:33], v[32:33], v[36:37]
    v_pk_mul_f32 v[34:35], v[34:35], v[38:39]
    v_cvt_pk_bf16_f32 v68, v32, v33
    v_cvt_pk_bf16_f32 v69, v34, v35
    buffer_store_dwordx2 v[68:69], v235, s[48:51], 0 offen offset:2048 sc1
    s_cmp_lg_u32 s66, 0
    s_cbranch_scc1 Lz_5
    s_cmp_eq_u32 s14, 0
    s_cselect_b32 s71, 1, 0
    s_cmp_eq_u32 s14, 248
    s_cselect_b32 s71, 2, s71
    s_cmp_eq_u32 s71, 0
    s_cbranch_scc1 Lz_5
    v_lshlrev_b32 v4, 8, v1
    v_mov_b32 v36, 0
    v_mov_b32 v37, 0
    v_mov_b32 v38, 0
    v_mov_b32 v39, 0
    s_mov_b64 exec, 0xfffff
    s_mov_b32 s74, 2606320
    s_cmp_eq_u32 s71, 1
    s_cselect_b32 s74, 0, s74
    buffer_store_dwordx4 v[36:39], v4, s[48:51], s74 offen sc1
    s_mov_b32 s74, 2616544
    s_cmp_eq_u32 s71, 1
    s_cselect_b32 s74, 10240, s74
    buffer_store_dwordx4 v[36:39], v4, s[48:51], s74 offen sc1
    s_mov_b32 s74, 2616560
    s_cmp_eq_u32 s71, 1
    s_cselect_b32 s74, 10256, s74
    buffer_store_dwordx4 v[36:39], v4, s[48:51], s74 offen sc1
    s_mov_b64 exec, -1
Lz_5:
    s_lshr_b32 s5, s96, 2
    s_and_b32 s3, s96, 3
    s_and_b32 s6, s97, 7
    s_lshl_b32 s5, s5, 3
    s_add_u32 s77, s5, s6
    s_lshr_b32 s4, s97, 3
    s_lshl_b32 s4, s4, 2
    s_add_u32 s78, s4, s3
    s_lshl_b32 s14, s77, 4
    s_add_u32 s14, s14, s78
    s_add_u32 s14, s14, 256
    s_min_u32 s78, s78, 14
    s_lshl_b32 s64, s77, 7
    s_lshl_b32 s65, s78, 7
    s_mov_b32 s48, s38
    s_mov_b32 s49, s39
    s_mov_b32 s50, 7864320
    s_mov_b32 s51, 0x00020000
    s_lshr_b32 s71, s66, 1
    s_and_b32 s72, s66, 1
    s_mul_i32 s73, s71, 64
    s_add_u32 s73, s73, s64
    s_mul_i32 s73, s73, 3840
    s_mul_i32 s74, s72, 64
    s_add_u32 s74, s74, s65
    s_lshl_b32 s72, s74, 1
    s_add_u32 s73, s73, s72
    s_mul_i32 s71, s66, 9216
    s_add_u32 s71, s71, 92160
    s_mov_b32 s72, 3840
    v_lshrrev_b32 v5, 3, v1
    v_and_b32 v6, 7, v1
    v_mul_u32_u24 v7, 144, v5
    v_lshl_add_u32 v7, v6, 4, v7
    v_add_u32 v232, s71, v7
    v_lshlrev_b32 v6, 4, v6
    v_mad_u32_u24 v7, v5, s72, v6
    v_add_u32 v233, s73, v7
    v_and_b32 v2, 15, v1
    v_lshrrev_b32 v3, 4, v1
    s_lshr_b32 s71, s66, 1
    s_and_b32 s72, s66, 1
    v_bfe_u32 v4, v2, 1, 3
    v_xor_b32 v4, v4, v3
    v_lshlrev_b32 v4, 4, v4
    v_lshl_add_u32 v4, v2, 7, v4
    s_mul_i32 s73, s71, 8192
    v_add_u32 v8, s73, v4
    v_xor_b32 v9, 64, v8
    v_lshrrev_b32 v4, 2, v2
    v_lshl_add_u32 v4, v3, 3, v4
    v_mov_b32 v6, 0
    v_bfe_u32 v5, v4, 0, 1
    v_lshl_or_b32 v6, v5, 0, v6
    v_bfe_u32 v5, v4, 1, 1
    v_lshl_or_b32 v6, v5, 1, v6
    v_bfe_u32 v5, v4, 3, 1
    v_lshl_or_b32 v6, v5, 2, v6
    v_mul_u32_u24 v4, 256, v4
    v_and_b32 v5, 3, v2
    v_lshl_add_u32 v4, v5, 3, v4
    v_add_u32 v4, 16384, v4
    s_mul_i32 s74, s72, 4
    s_add_u32 s73, s74, 0
    v_xor_b32 v5, s73, v6
    v_lshl_add_u32 v244, v5, 5, v4
    s_add_u32 s73, s74, 1
    v_xor_b32 v5, s73, v6
    v_lshl_add_u32 v245, v5, 5, v4
    s_add_u32 s73, s74, 2
    v_xor_b32 v5, s73, v6
    v_lshl_add_u32 v246, v5, 5, v4
    s_add_u32 s73, s74, 3
    v_xor_b32 v5, s73, v6
    v_lshl_add_u32 v247, v5, 5, v4
    s_mul_i32 s73, s66, 9216
    s_add_u32 s73, s73, 92160
    v_mul_u32_u24 v4, 144, v2
    v_lshl_add_u32 v4, v3, 3, v4
    v_add_u32 v12, s73, v4
    v_mov_b32 v16, 0
    v_mov_b32 v17, 0
    v_mov_b32 v18, 0
    v_mov_b32 v19, 0
    v_mov_b32 v20, 0
    v_mov_b32 v21, 0
    v_mov_b32 v22, 0
    v_mov_b32 v23, 0
    v_mov_b32 v24, 0
    v_mov_b32 v25, 0
    v_mov_b32 v26, 0
    v_mov_b32 v27, 0
    v_mov_b32 v28, 0
    v_mov_b32 v29, 0
    v_mov_b32 v30, 0
    v_mov_b32 v31, 0
    v_mov_b32 v32, 0
    v_mov_b32 v33, 0
    v_mov_b32 v34, 0
    v_mov_b32 v35, 0
    v_mov_b32 v36, 0
    v_mov_b32 v37, 0
    v_mov_b32 v38, 0
    v_mov_b32 v39, 0
    v_mov_b32 v40, 0
    v_mov_b32 v41, 0
    v_mov_b32 v42, 0
    v_mov_b32 v43, 0
    v_mov_b32 v44, 0
    v_mov_b32 v45, 0
    v_mov_b32 v46, 0
    v_mov_b32 v47, 0
    v_mov_b32 v48, 0
    v_mov_b32 v49, 0
    v_mov_b32 v50, 0
    v_mov_b32 v51, 0
    v_mov_b32 v52, 0
    v_mov_b32 v53, 0
    v_mov_b32 v54, 0
    v_mov_b32 v55, 0
    v_mov_b32 v56, 0
    v_mov_b32 v57, 0
    v_mov_b32 v58, 0
    v_mov_b32 v59, 0
    v_mov_b32 v60, 0
    v_mov_b32 v61, 0
    v_mov_b32 v62, 0
    v_mov_b32 v63, 0
    v_mov_b32 v64, 0
    v_mov_b32 v65, 0
    v_mov_b32 v66, 0
    v_mov_b32 v67, 0
    v_mov_b32 v68, 0
    v_mov_b32 v69, 0
    v_mov_b32 v70, 0
    v_mov_b32 v71, 0
    v_mov_b32 v72, 0
    v_mov_b32 v73, 0
    v_mov_b32 v74, 0
    v_mov_b32 v75, 0
    v_mov_b32 v76, 0
    v_mov_b32 v77, 0
    v_mov_b32 v78, 0
    v_mov_b32 v79, 0
    s_mov_b32 s69, 0
    s_barrier
    ds_read_b128 v[80:83], v8 offset:0
    ds_read_b128 v[84:87], v8 offset:2048
    ds_read_b128 v[88:91], v8 offset:4096
    ds_read_b128 v[92:95], v8 offset:6144
    ds_read_b64_tr_b16 v[96:97], v244 offset:0
    ds_read_b64_tr_b16 v[98:99], v244 offset:1024
    ds_read_b64_tr_b16 v[100:101], v245 offset:0
    ds_read_b64_tr_b16 v[102:103], v245 offset:1024
    ds_read_b64_tr_b16 v[104:105], v246 offset:0
    ds_read_b64_tr_b16 v[106:107], v246 offset:1024
    ds_read_b64_tr_b16 v[108:109], v247 offset:0
    ds_read_b64_tr_b16 v[110:111], v247 offset:1024
    s_mov_b32 s70, 9
Lc_6:
    s_waitcnt lgkmcnt(0)
    v_mfma_f32_16x16x32_bf16 v[16:19], v[96:99], v[80:83], v[16:19]
    ds_read_b128 v[112:115], v9 offset:0
    v_mfma_f32_16x16x32_bf16 v[32:35], v[96:99], v[84:87], v[32:35]
    ds_read_b128 v[116:119], v9 offset:2048
    v_mfma_f32_16x16x32_bf16 v[48:51], v[96:99], v[88:91], v[48:51]
    ds_read_b128 v[120:123], v9 offset:4096
    v_mfma_f32_16x16x32_bf16 v[64:67], v[96:99], v[92:95], v[64:67]
    ds_read_b128 v[124:127], v9 offset:6144
    v_mfma_f32_16x16x32_bf16 v[20:23], v[100:103], v[80:83], v[20:23]
    ds_read_b64_tr_b16 v[128:129], v244 offset:8192
    v_mfma_f32_16x16x32_bf16 v[36:39], v[100:103], v[84:87], v[36:39]
    ds_read_b64_tr_b16 v[130:131], v244 offset:9216
    v_mfma_f32_16x16x32_bf16 v[52:55], v[100:103], v[88:91], v[52:55]
    ds_read_b64_tr_b16 v[132:133], v245 offset:8192
    v_mfma_f32_16x16x32_bf16 v[68:71], v[100:103], v[92:95], v[68:71]
    ds_read_b64_tr_b16 v[134:135], v245 offset:9216
    v_mfma_f32_16x16x32_bf16 v[24:27], v[104:107], v[80:83], v[24:27]
    ds_read_b64_tr_b16 v[136:137], v246 offset:8192
    v_mfma_f32_16x16x32_bf16 v[40:43], v[104:107], v[84:87], v[40:43]
    ds_read_b64_tr_b16 v[138:139], v246 offset:9216
    v_mfma_f32_16x16x32_bf16 v[56:59], v[104:107], v[88:91], v[56:59]
    ds_read_b64_tr_b16 v[140:141], v247 offset:8192
    v_mfma_f32_16x16x32_bf16 v[72:75], v[104:107], v[92:95], v[72:75]
    ds_read_b64_tr_b16 v[142:143], v247 offset:9216
    v_mfma_f32_16x16x32_bf16 v[28:31], v[108:111], v[80:83], v[28:31]
    v_mfma_f32_16x16x32_bf16 v[44:47], v[108:111], v[84:87], v[44:47]
    v_mfma_f32_16x16x32_bf16 v[60:63], v[108:111], v[88:91], v[60:63]
    v_mfma_f32_16x16x32_bf16 v[76:79], v[108:111], v[92:95], v[76:79]
    s_add_u32 s69, s69, 32768
    s_cmp_ge_u32 s69, 163840
    s_cselect_b32 s73, 163840, 0
    s_sub_u32 s69, s69, s73
    s_sub_u32 s73, 32768, s73
    v_add_u32 v8, s73, v8
    v_add_u32 v9, s73, v9
    v_add_u32 v244, s73, v244
    v_add_u32 v245, s73, v245
    v_add_u32 v246, s73, v246
    v_add_u32 v247, s73, v247
    s_waitcnt lgkmcnt(0)
    v_mfma_f32_16x16x32_bf16 v[16:19], v[128:131], v[112:115], v[16:19]
    ds_read_b128 v[80:83], v8 offset:0
    v_mfma_f32_16x16x32_bf16 v[32:35], v[128:131], v[116:119], v[32:35]
    ds_read_b128 v[84:87], v8 offset:2048
    v_mfma_f32_16x16x32_bf16 v[48:51], v[128:131], v[120:123], v[48:51]
    ds_read_b128 v[88:91], v8 offset:4096
    v_mfma_f32_16x16x32_bf16 v[64:67], v[128:131], v[124:127], v[64:67]
    ds_read_b128 v[92:95], v8 offset:6144
    v_mfma_f32_16x16x32_bf16 v[20:23], v[132:135], v[112:115], v[20:23]
    ds_read_b64_tr_b16 v[96:97], v244 offset:0
    v_mfma_f32_16x16x32_bf16 v[36:39], v[132:135], v[116:119], v[36:39]
    ds_read_b64_tr_b16 v[98:99], v244 offset:1024
    v_mfma_f32_16x16x32_bf16 v[52:55], v[132:135], v[120:123], v[52:55]
    ds_read_b64_tr_b16 v[100:101], v245 offset:0
    v_mfma_f32_16x16x32_bf16 v[68:71], v[132:135], v[124:127], v[68:71]
    ds_read_b64_tr_b16 v[102:103], v245 offset:1024
    v_mfma_f32_16x16x32_bf16 v[24:27], v[136:139], v[112:115], v[24:27]
    ds_read_b64_tr_b16 v[104:105], v246 offset:0
    v_mfma_f32_16x16x32_bf16 v[40:43], v[136:139], v[116:119], v[40:43]
    ds_read_b64_tr_b16 v[106:107], v246 offset:1024
    v_mfma_f32_16x16x32_bf16 v[56:59], v[136:139], v[120:123], v[56:59]
    ds_read_b64_tr_b16 v[108:109], v247 offset:0
    v_mfma_f32_16x16x32_bf16 v[72:75], v[136:139], v[124:127], v[72:75]
    ds_read_b64_tr_b16 v[110:111], v247 offset:1024
    v_mfma_f32_16x16x32_bf16 v[28:31], v[140:143], v[112:115], v[28:31]
    v_mfma_f32_16x16x32_bf16 v[44:47], v[140:143], v[116:119], v[44:47]
    v_mfma_f32_16x16x32_bf16 v[60:63], v[140:143], v[120:123], v[60:63]
    v_mfma_f32_16x16x32_bf16 v[76:79], v[140:143], v[124:127], v[76:79]
    s_cmp_lg_u32 s70, 7
    s_cbranch_scc1 Ldr_7
    s_waitcnt vmcnt(0)
Ldr_7:
    s_cmp_lg_u32 s70, 5
    s_cbranch_scc1 Lmid_8
    s_mov_b32 s92, s38
    s_mov_b32 s93, s39
    s_mov_b32 s94, 41943040
    s_mov_b32 s95, 0x00020000
    buffer_store_dwordx4 v[150:153], v162, s[92:95], 0 offen sc1
    buffer_store_dwordx4 v[154:157], v163, s[92:95], 0 offen sc1
    buffer_store_dwordx4 v[158:161], v164, s[92:95], 0 offen sc1
Lmid_8:
    s_barrier
    s_sub_u32 s70, s70, 1
    s_cmp_lg_u32 s70, 0
    s_cbranch_scc1 Lc_6
    s_waitcnt lgkmcnt(0)
    v_mfma_f32_16x16x32_bf16 v[16:19], v[96:99], v[80:83], v[16:19]
    ds_read_b128 v[112:115], v9 offset:0
    v_mfma_f32_16x16x32_bf16 v[32:35], v[96:99], v[84:87], v[32:35]
    ds_read_b128 v[116:119], v9 offset:2048
    v_mfma_f32_16x16x32_bf16 v[48:51], v[96:99], v[88:91], v[48:51]
    ds_read_b128 v[120:123], v9 offset:4096
    v_mfma_f32_16x16x32_bf16 v[64:67], v[96:99], v[92:95], v[64:67]
    ds_read_b128 v[124:127], v9 offset:6144
    v_mfma_f32_16x16x32_bf16 v[20:23], v[100:103], v[80:83], v[20:23]
    ds_read_b64_tr_b16 v[128:129], v244 offset:8192
    v_mfma_f32_16x16x32_bf16 v[36:39], v[100:103], v[84:87], v[36:39]
    ds_read_b64_tr_b16 v[130:131], v244 offset:9216
    v_mfma_f32_16x16x32_bf16 v[52:55], v[100:103], v[88:91], v[52:55]
    ds_read_b64_tr_b16 v[132:133], v245 offset:8192
    v_mfma_f32_16x16x32_bf16 v[68:71], v[100:103], v[92:95], v[68:71]
    ds_read_b64_tr_b16 v[134:135], v245 offset:9216
    v_mfma_f32_16x16x32_bf16 v[24:27], v[104:107], v[80:83], v[24:27]
    ds_read_b64_tr_b16 v[136:137], v246 offset:8192
    v_mfma_f32_16x16x32_bf16 v[40:43], v[104:107], v[84:87], v[40:43]
    ds_read_b64_tr_b16 v[138:139], v246 offset:9216
    v_mfma_f32_16x16x32_bf16 v[56:59], v[104:107], v[88:91], v[56:59]
    ds_read_b64_tr_b16 v[140:141], v247 offset:8192
    v_mfma_f32_16x16x32_bf16 v[72:75], v[104:107], v[92:95], v[72:75]
    ds_read_b64_tr_b16 v[142:143], v247 offset:9216
    v_mfma_f32_16x16x32_bf16 v[28:31], v[108:111], v[80:83], v[28:31]
    v_mfma_f32_16x16x32_bf16 v[44:47], v[108:111], v[84:87], v[44:47]
    v_mfma_f32_16x16x32_bf16 v[60:63], v[108:111], v[88:91], v[60:63]
    v_mfma_f32_16x16x32_bf16 v[76:79], v[108:111], v[92:95], v[76:79]
    s_waitcnt lgkmcnt(0)
    v_mfma_f32_16x16x32_bf16 v[16:19], v[128:131], v[112:115], v[16:19]
    v_mfma_f32_16x16x32_bf16 v[32:35], v[128:131], v[116:119], v[32:35]
    v_mfma_f32_16x16x32_bf16 v[48:51], v[128:131], v[120:123], v[48:51]
    v_mfma_f32_16x16x32_bf16 v[64:67], v[128:131], v[124:127], v[64:67]
    v_mfma_f32_16x16x32_bf16 v[20:23], v[132:135], v[112:115], v[20:23]
    v_mfma_f32_16x16x32_bf16 v[36:39], v[132:135], v[116:119], v[36:39]
    v_mfma_f32_16x16x32_bf16 v[52:55], v[132:135], v[120:123], v[52:55]
    v_mfma_f32_16x16x32_bf16 v[68:71], v[132:135], v[124:127], v[68:71]
    v_mfma_f32_16x16x32_bf16 v[24:27], v[136:139], v[112:115], v[24:27]
    v_mfma_f32_16x16x32_bf16 v[40:43], v[136:139], v[116:119], v[40:43]
    v_mfma_f32_16x16x32_bf16 v[56:59], v[136:139], v[120:123], v[56:59]
    v_mfma_f32_16x16x32_bf16 v[72:75], v[136:139], v[124:127], v[72:75]
    v_mfma_f32_16x16x32_bf16 v[28:31], v[140:143], v[112:115], v[28:31]
    v_mfma_f32_16x16x32_bf16 v[44:47], v[140:143], v[116:119], v[44:47]
    v_mfma_f32_16x16x32_bf16 v[60:63], v[140:143], v[120:123], v[60:63]
    v_mfma_f32_16x16x32_bf16 v[76:79], v[140:143], v[124:127], v[76:79]
    s_nop 9
    s_mov_b32 s52, s16
    s_mov_b32 s53, s17
    s_mov_b32 s54, 2621440
    s_mov_b32 s55, 0x00020000
    buffer_load_dwordx2 v[222:223], v199, s[52:55], 0 offen offset:0
    buffer_load_dwordx2 v[224:225], v199, s[52:55], 0 offen offset:32
    buffer_load_dwordx2 v[226:227], v199, s[52:55], 0 offen offset:64
    buffer_load_dwordx2 v[228:229], v199, s[52:55], 0 offen offset:96
    buffer_load_dwordx2 v[230:231], v199, s[52:55], 0 offen offset:128
    v_cvt_pk_bf16_f32 v80, v16, v17
    v_cvt_pk_bf16_f32 v81, v18, v19
    ds_write_b64 v12, v[80:81] offset:0
    v_cvt_pk_bf16_f32 v82, v20, v21
    v_cvt_pk_bf16_f32 v83, v22, v23
    ds_write_b64 v12, v[82:83] offset:32
    v_cvt_pk_bf16_f32 v84, v24, v25
    v_cvt_pk_bf16_f32 v85, v26, v27
    ds_write_b64 v12, v[84:85] offset:64
    v_cvt_pk_bf16_f32 v86, v28, v29
    v_cvt_pk_bf16_f32 v87, v30, v31
    ds_write_b64 v12, v[86:87] offset:96
    v_cvt_pk_bf16_f32 v88, v32, v33
    v_cvt_pk_bf16_f32 v89, v34, v35
    ds_write_b64 v12, v[88:89] offset:2304
    v_cvt_pk_bf16_f32 v90, v36, v37
    v_cvt_pk_bf16_f32 v91, v38, v39
    ds_write_b64 v12, v[90:91] offset:2336
    v_cvt_pk_bf16_f32 v92, v40, v41
    v_cvt_pk_bf16_f32 v93, v42, v43
    ds_write_b64 v12, v[92:93] offset:2368
    v_cvt_pk_bf16_f32 v94, v44, v45
    v_cvt_pk_bf16_f32 v95, v46, v47
    ds_write_b64 v12, v[94:95] offset:2400
    v_cvt_pk_bf16_f32 v80, v48, v49
    v_cvt_pk_bf16_f32 v81, v50, v51
    ds_write_b64 v12, v[80:81] offset:4608
    v_cvt_pk_bf16_f32 v82, v52, v53
    v_cvt_pk_bf16_f32 v83, v54, v55
    ds_write_b64 v12, v[82:83] offset:4640
    v_cvt_pk_bf16_f32 v84, v56, v57
    v_cvt_pk_bf16_f32 v85, v58, v59
    ds_write_b64 v12, v[84:85] offset:4672
    v_cvt_pk_bf16_f32 v86, v60, v61
    v_cvt_pk_bf16_f32 v87, v62, v63
    ds_write_b64 v12, v[86:87] offset:4704
    v_cvt_pk_bf16_f32 v88, v64, v65
    v_cvt_pk_bf16_f32 v89, v66, v67
    ds_write_b64 v12, v[88:89] offset:6912
    v_cvt_pk_bf16_f32 v90, v68, v69
    v_cvt_pk_bf16_f32 v91, v70, v71
    ds_write_b64 v12, v[90:91] offset:6944
    v_cvt_pk_bf16_f32 v92, v72, v73
    v_cvt_pk_bf16_f32 v93, v74, v75
    ds_write_b64 v12, v[92:93] offset:6976
    v_cvt_pk_bf16_f32 v94, v76, v77
    v_cvt_pk_bf16_f32 v95, v78, v79
    ds_write_b64 v12, v[94:95] offset:7008
    s_waitcnt lgkmcnt(0)
    ds_read_b128 v[16:19], v232 offset:0
    ds_read_b128 v[20:23], v232 offset:1152
    ds_read_b128 v[24:27], v232 offset:2304
    ds_read_b128 v[28:31], v232 offset:3456
    ds_read_b128 v[32:35], v232 offset:4608
    ds_read_b128 v[36:39], v232 offset:5760
    ds_read_b128 v[40:43], v232 offset:6912
    ds_read_b128 v[44:47], v232 offset:8064
    s_waitcnt lgkmcnt(7)
    buffer_store_dwordx4 v[16:19], v233, s[48:51], 0 offen sc1
    s_waitcnt lgkmcnt(6)
    s_mov_b32 s88, 30720
    buffer_store_dwordx4 v[20:23], v233, s[48:51], s88 offen sc1
    s_waitcnt lgkmcnt(5)
    s_mov_b32 s88, 61440
    buffer_store_dwordx4 v[24:27], v233, s[48:51], s88 offen sc1
    s_waitcnt lgkmcnt(4)
    s_mov_b32 s88, 92160
    buffer_store_dwordx4 v[28:31], v233, s[48:51], s88 offen sc1
    s_waitcnt lgkmcnt(3)
    s_mov_b32 s88, 122880
    buffer_store_dwordx4 v[32:35], v233, s[48:51], s88 offen sc1
    s_waitcnt lgkmcnt(2)
    s_mov_b32 s88, 153600
    buffer_store_dwordx4 v[36:39], v233, s[48:51], s88 offen sc1
    s_waitcnt lgkmcnt(1)
    s_mov_b32 s88, 184320
    buffer_store_dwordx4 v[40:43], v233, s[48:51], s88 offen sc1
    s_waitcnt lgkmcnt(0)
    s_mov_b32 s88, 215040
    buffer_store_dwordx4 v[44:47], v233, s[48:51], s88 offen sc1
    s_lshr_b32 s5, s96, 1
    s_and_b32 s3, s96, 1
    s_and_b32 s6, s97, 7
    s_lshl_b32 s5, s5, 3
    s_add_u32 s77, s5, s6
    s_lshr_b32 s4, s97, 3
    s_lshl_b32 s3, s3, 2
    s_add_u32 s78, s3, s4
    s_lshl_b32 s64, s77, 6
    s_mul_i32 s65, s78, 80
    s_lshl_b32 s14, s77, 3
    s_add_u32 s14, s14, s78
    s_add_u32 s14, s14, 512
    s_add_u32 s48, s38, 14680064
    s_addc_u32 s49, s39, 0
    s_mov_b32 s50, 2621440
    s_mov_b32 s51, 0x00020000
    s_mov_b32 s52, s16
    s_mov_b32 s53, s17
    s_mov_b32 s54, 2621440
    s_mov_b32 s55, 0x00020000
    s_add_u32 s60, s38, 29360128
    s_addc_u32 s61, s39, 0
    s_mov_b32 s62, 262144
    s_mov_b32 s63, 0x00020000
    s_mul_i32 s71, s66, 16
    s_add_u32 s71, s71, s64
    v_and_b32 v4, 15, v1
    v_add_u32 v4, s71, v4
    v_lshrrev_b32 v5, 4, v4
    v_mul_u32_u24 v5, 20480, v5
    v_and_b32 v4, 15, v4
    v_lshl_add_u32 v5, v4, 4, v5
    s_lshl_b32 s72, s65, 5
    v_add_u32 v5, s72, v5
    v_lshrrev_b32 v6, 4, v1
    v_and_b32 v7, 1, v6
    v_lshrrev_b32 v6, 1, v6
    v_lshl_add_u32 v4, v6, 8, v5
    v_lshl_add_u32 v234, v7, 9, v4
    v_lshl_add_u32 v235, v7, 3, v4
    v_mov_b32 v242, v4
    v_mov_b32 v243, v7
    v_and_b32 v2, 15, v1
    v_lshrrev_b32 v3, 4, v1
    s_mov_b32 s71, s66
    s_mov_b32 s72, 0
    v_lshlrev_b32 v4, 4, v1
    s_mul_i32 s73, s71, 2048
    v_add_u32 v8, s73, v4
    v_lshrrev_b32 v4, 2, v2
    v_and_b32 v5, 1, v3
    v_lshl_add_u32 v4, v5, 2, v4
    v_lshrrev_b32 v5, 1, v3
    v_lshl_add_u32 v4, v5, 4, v4
    v_mul_u32_u24 v4, 160, v4
    v_and_b32 v5, 3, v2
    v_lshl_add_u32 v4, v5, 3, v4
    v_add_u32 v244, 8192, v4
    s_mul_i32 s73, s66, 2816
    s_add_u32 s73, s73, 102400
    v_mul_u32_u24 v4, 176, v2
    v_lshl_add_u32 v4, v3, 3, v4
    v_add_u32 v12, s73, v4
    v_mov_b32 v16, 0
    v_mov_b32 v17, 0
    v_mov_b32 v18, 0
    v_mov_b32 v19, 0
    v_mov_b32 v20, 0
    v_mov_b32 v21, 0
    v_mov_b32 v22, 0
    v_mov_b32 v23, 0
    v_mov_b32 v24, 0
    v_mov_b32 v25, 0
    v_mov_b32 v26, 0
    v_mov_b32 v27, 0
    v_mov_b32 v28, 0
    v_mov_b32 v29, 0
    v_mov_b32 v30, 0
    v_mov_b32 v31, 0
    v_mov_b32 v32, 0
    v_mov_b32 v33, 0
    v_mov_b32 v34, 0
    v_mov_b32 v35, 0
    s_mov_b32 s69, 0
    s_barrier
    ds_read_b128 v[36:39], v8 offset:0
    ds_read_b64_tr_b16 v[40:41], v244 offset:0
    ds_read_b64_tr_b16 v[42:43], v244 offset:1280
    ds_read_b64_tr_b16 v[44:45], v244 offset:32
    ds_read_b64_tr_b16 v[46:47], v244 offset:1312
    ds_read_b64_tr_b16 v[48:49], v244 offset:64
    ds_read_b64_tr_b16 v[50:51], v244 offset:1344
    ds_read_b64_tr_b16 v[52:53], v244 offset:96
    ds_read_b64_tr_b16 v[54:55], v244 offset:1376
    ds_read_b64_tr_b16 v[56:57], v244 offset:128
    ds_read_b64_tr_b16 v[58:59], v244 offset:1408
    s_mov_b32 s70, 9
Lc_9:
    s_waitcnt lgkmcnt(0)
    v_mfma_f32_16x16x32_bf16 v[16:19], v[40:43], v[36:39], v[16:19]
    ds_read_b128 v[60:63], v8 offset:1024
    ds_read_b64_tr_b16 v[64:65], v244 offset:5120
    ds_read_b64_tr_b16 v[66:67], v244 offset:6400
    ds_read_b64_tr_b16 v[68:69], v244 offset:5152
    v_mfma_f32_16x16x32_bf16 v[20:23], v[44:47], v[36:39], v[20:23]
    ds_read_b64_tr_b16 v[70:71], v244 offset:6432
    ds_read_b64_tr_b16 v[72:73], v244 offset:5184
    ds_read_b64_tr_b16 v[74:75], v244 offset:6464
    ds_read_b64_tr_b16 v[76:77], v244 offset:5216
    v_mfma_f32_16x16x32_bf16 v[24:27], v[48:51], v[36:39], v[24:27]
    ds_read_b64_tr_b16 v[78:79], v244 offset:6496
    ds_read_b64_tr_b16 v[80:81], v244 offset:5248
    ds_read_b64_tr_b16 v[82:83], v244 offset:6528
    v_mfma_f32_16x16x32_bf16 v[28:31], v[52:55], v[36:39], v[28:31]
    v_mfma_f32_16x16x32_bf16 v[32:35], v[56:59], v[36:39], v[32:35]
    s_add_u32 s69, s69, 20480
    s_cmp_ge_u32 s69, 102400
    s_cselect_b32 s73, 102400, 0
    s_sub_u32 s69, s69, s73
    s_sub_u32 s73, 20480, s73
    v_add_u32 v8, s73, v8
    v_add_u32 v244, s73, v244
    s_waitcnt lgkmcnt(0)
    v_mfma_f32_16x16x32_bf16 v[16:19], v[64:67], v[60:63], v[16:19]
    ds_read_b128 v[36:39], v8 offset:0
    ds_read_b64_tr_b16 v[40:41], v244 offset:0
    ds_read_b64_tr_b16 v[42:43], v244 offset:1280
    ds_read_b64_tr_b16 v[44:45], v244 offset:32
    v_mfma_f32_16x16x32_bf16 v[20:23], v[68:71], v[60:63], v[20:23]
    ds_read_b64_tr_b16 v[46:47], v244 offset:1312
    ds_read_b64_tr_b16 v[48:49], v244 offset:64
    ds_read_b64_tr_b16 v[50:51], v244 offset:1344
    ds_read_b64_tr_b16 v[52:53], v244 offset:96
    v_mfma_f32_16x16x32_bf16 v[24:27], v[72:75], v[60:63], v[24:27]
    ds_read_b64_tr_b16 v[54:55], v244 offset:1376
    ds_read_b64_tr_b16 v[56:57], v244 offset:128
    ds_read_b64_tr_b16 v[58:59], v244 offset:1408
    v_mfma_f32_16x16x32_bf16 v[28:31], v[76:79], v[60:63], v[28:31]
    v_mfma_f32_16x16x32_bf16 v[32:35], v[80:83], v[60:63], v[32:35]
    s_cmp_lg_u32 s70, 7
    s_cbranch_scc1 Ldr_10
    s_waitcnt vmcnt(0)
Ldr_10:
    s_barrier
    s_sub_u32 s70, s70, 1
    s_cmp_lg_u32 s70, 0
    s_cbranch_scc1 Lc_9
    s_waitcnt lgkmcnt(0)
    v_mfma_f32_16x16x32_bf16 v[16:19], v[40:43], v[36:39], v[16:19]
    ds_read_b128 v[60:63], v8 offset:1024
    ds_read_b64_tr_b16 v[64:65], v244 offset:5120
    ds_read_b64_tr_b16 v[66:67], v244 offset:6400
    ds_read_b64_tr_b16 v[68:69], v244 offset:5152
    v_mfma_f32_16x16x32_bf16 v[20:23], v[44:47], v[36:39], v[20:23]
    ds_read_b64_tr_b16 v[70:71], v244 offset:6432
    ds_read_b64_tr_b16 v[72:73], v244 offset:5184
    ds_read_b64_tr_b16 v[74:75], v244 offset:6464
    ds_read_b64_tr_b16 v[76:77], v244 offset:5216
    v_mfma_f32_16x16x32_bf16 v[24:27], v[48:51], v[36:39], v[24:27]
    ds_read_b64_tr_b16 v[78:79], v244 offset:6496
    ds_read_b64_tr_b16 v[80:81], v244 offset:5248
    ds_read_b64_tr_b16 v[82:83], v244 offset:6528
    v_mfma_f32_16x16x32_bf16 v[28:31], v[52:55], v[36:39], v[28:31]
    v_mfma_f32_16x16x32_bf16 v[32:35], v[56:59], v[36:39], v[32:35]
    s_waitcnt lgkmcnt(0)
    v_mfma_f32_16x16x32_bf16 v[16:19], v[64:67], v[60:63], v[16:19]
    v_mfma_f32_16x16x32_bf16 v[20:23], v[68:71], v[60:63], v[20:23]
    v_mfma_f32_16x16x32_bf16 v[24:27], v[72:75], v[60:63], v[24:27]
    v_mfma_f32_16x16x32_bf16 v[28:31], v[76:79], v[60:63], v[28:31]
    v_mfma_f32_16x16x32_bf16 v[32:35], v[80:83], v[60:63], v[32:35]
    s_nop 9
    s_mov_b32 s56, s32
    s_mov_b32 s57, s33
    s_mov_b32 s58, 1280
    s_mov_b32 s59, 0x00020000
    s_lshl_b32 s71, s78, 3
    s_add_u32 s71, s71, s64
    v_lshrrev_b32 v4, 5, v0
    v_and_b32 v5, 31, v0
    v_mul_u32_u24 v6, 40, v5
    v_add_u32 v4, s71, v4
    s_mov_b32 s73, 1280
    v_mad_u32_u24 v5, v4, s73, v6
    buffer_load_dwordx4 v[150:153], v5, s[52:55], 0 offen
    buffer_load_dwordx4 v[154:157], v5, s[52:55], 0 offen offset:16
    buffer_load_dwordx2 v[158:159], v5, s[52:55], 0 offen offset:32
    buffer_load_dwordx4 v[160:163], v6, s[56:59], 0 offen
    buffer_load_dwordx4 v[164:167], v6, s[56:59], 0 offen offset:16
    buffer_load_dwordx2 v[168:169], v6, s[56:59], 0 offen offset:32
    s_mul_i32 s71, s77, 54
    s_mul_i32 s72, s78, 160
    s_mul_i32 s73, s78, 276480
    s_add_u32 s73, s73, 38797312
    s_mov_b32 s92, s30
    s_mov_b32 s93, s31
    s_mov_b32 s94, 2211840
    s_mov_b32 s95, 0x00020000
    v_add_u32 v4, 0, v0
    v_mul_u32_u24 v5, 6554, v4
    v_lshrrev_b32 v5, 16, v5
    v_mul_u32_u24 v6, 10, v5
    v_sub_u32 v6, v4, v6
    v_lshlrev_b32 v6, 4, v6
    v_cmp_gt_u32 vcc, 540, v4
    v_add_u32 v5, s71, v5
    v_mul_u32_u24 v7, 1280, v5
    v_add3_u32 v7, v7, v6, s72
    v_bfrev_b32 v4, 1
    v_cndmask_b32 v7, v4, v7, vcc
    buffer_load_dwordx4 v[176:179], v7, s[92:95], 0 offen
    v_bfe_u32 v7, v5, 2, 1
    v_bfe_u32 v188, v5, 3, 1
    v_and_b32 v5, 0xfffffff3, v5
    v_lshl_or_b32 v5, v7, 3, v5
    v_lshl_or_b32 v5, v188, 2, v5
    v_mul_u32_u24 v5, 160, v5
    v_add3_u32 v5, v5, v6, s73
    v_cndmask_b32 v188, v4, v5, vcc
    v_add_u32 v4, 256, v0
    v_mul_u32_u24 v5, 6554, v4
    v_lshrrev_b32 v5, 16, v5
    v_mul_u32_u24 v6, 10, v5
    v_sub_u32 v6, v4, v6
    v_lshlrev_b32 v6, 4, v6
    v_cmp_gt_u32 vcc, 540, v4
    v_add_u32 v5, s71, v5
    v_mul_u32_u24 v7, 1280, v5
    v_add3_u32 v7, v7, v6, s72
    v_bfrev_b32 v4, 1
    v_cndmask_b32 v7, v4, v7, vcc
    buffer_load_dwordx4 v[180:183], v7, s[92:95], 0 offen
    v_bfe_u32 v7, v5, 2, 1
    v_bfe_u32 v189, v5, 3, 1
    v_and_b32 v5, 0xfffffff3, v5
    v_lshl_or_b32 v5, v7, 3, v5
    v_lshl_or_b32 v5, v189, 2, v5
    v_mul_u32_u24 v5, 160, v5
    v_add3_u32 v5, v5, v6, s73
    v_cndmask_b32 v189, v4, v5, vcc
    v_add_u32 v4, 512, v0
    v_mul_u32_u24 v5, 6554, v4
    v_lshrrev_b32 v5, 16, v5
    v_mul_u32_u24 v6, 10, v5
    v_sub_u32 v6, v4, v6
    v_lshlrev_b32 v6, 4, v6
    v_cmp_gt_u32 vcc, 540, v4
    v_add_u32 v5, s71, v5
    v_mul_u32_u24 v7, 1280, v5
    v_add3_u32 v7, v7, v6, s72
    v_bfrev_b32 v4, 1
    v_cndmask_b32 v7, v4, v7, vcc
    buffer_load_dwordx4 v[184:187], v7, s[92:95], 0 offen
    v_bfe_u32 v7, v5, 2, 1
    v_bfe_u32 v190, v5, 3, 1
    v_and_b32 v5, 0xfffffff3, v5
    v_lshl_or_b32 v5, v7, 3, v5
    v_lshl_or_b32 v5, v190, 2, v5
    v_mul_u32_u24 v5, 160, v5
    v_add3_u32 v5, v5, v6, s73
    v_cndmask_b32 v190, v4, v5, vcc
    v_mov_b32 v48, 0
    v_mov_b32 v49, 0
    v_cvt_pk_bf16_f32 v40, v16, v17
    v_cvt_pk_bf16_f32 v41, v18, v19
    v_lshlrev_b32 v36, 16, v40
    v_and_b32 v37, 0xffff0000, v40
    v_lshlrev_b32 v38, 16, v41
    v_and_b32 v39, 0xffff0000, v41
    v_lshlrev_b32 v40, 16, v222
    v_and_b32 v41, 0xffff0000, v222
    v_lshlrev_b32 v42, 16, v223
    v_and_b32 v43, 0xffff0000, v223
    v_pk_add_f32 v[36:37], v[36:37], v[40:41]
    v_pk_add_f32 v[38:39], v[38:39], v[42:43]
    v_cvt_pk_bf16_f32 v200, v36, v37
    v_cvt_pk_bf16_f32 v201, v38, v39
    v_mov_b32 v60, v200
    v_mov_b32 v61, v201
    v_lshlrev_b32 v36, 16, v200
    v_and_b32 v37, 0xffff0000, v200
    v_lshlrev_b32 v38, 16, v201
    v_and_b32 v39, 0xffff0000, v201
    v_add_f32 v48, v48, v36
    v_fmac_f32 v49, v36, v36
    v_add_f32 v48, v48, v37
    v_fmac_f32 v49, v37, v37
    v_add_f32 v48, v48, v38
    v_fmac_f32 v49, v38, v38
    v_add_f32 v48, v48, v39
    v_fmac_f32 v49, v39, v39
    v_cvt_pk_bf16_f32 v40, v20, v21
    v_cvt_pk_bf16_f32 v41, v22, v23
    v_lshlrev_b32 v36, 16, v40
    v_and_b32 v37, 0xffff0000, v40
    v_lshlrev_b32 v38, 16, v41
    v_and_b32 v39, 0xffff0000, v41
    v_lshlrev_b32 v40, 16, v224
    v_and_b32 v41, 0xffff0000, v224
    v_lshlrev_b32 v42, 16, v225
    v_and_b32 v43, 0xffff0000, v225
    v_pk_add_f32 v[36:37], v[36:37], v[40:41]
    v_pk_add_f32 v[38:39], v[38:39], v[42:43]
    v_cvt_pk_bf16_f32 v202, v36, v37
    v_cvt_pk_bf16_f32 v203, v38, v39
    v_mov_b32 v62, v202
    v_mov_b32 v63, v203
    s_nop 1
    v_permlane16_swap_b32 v60, v62
    v_permlane16_swap_b32 v61, v63
    buffer_store_dwordx4 v[60:63], v234, s[48:51], 0 offen offset:0 sc1
    v_lshlrev_b32 v36, 16, v202
    v_and_b32 v37, 0xffff0000, v202
    v_lshlrev_b32 v38, 16, v203
    v_and_b32 v39, 0xffff0000, v203
    v_add_f32 v48, v48, v36
    v_fmac_f32 v49, v36, v36
    v_add_f32 v48, v48, v37
    v_fmac_f32 v49, v37, v37
    v_add_f32 v48, v48, v38
    v_fmac_f32 v49, v38, v38
    v_add_f32 v48, v48, v39
    v_fmac_f32 v49, v39, v39
    v_cvt_pk_bf16_f32 v40, v24, v25
    v_cvt_pk_bf16_f32 v41, v26, v27
    v_lshlrev_b32 v36, 16, v40
    v_and_b32 v37, 0xffff0000, v40
    v_lshlrev_b32 v38, 16, v41
    v_and_b32 v39, 0xffff0000, v41
    v_lshlrev_b32 v40, 16, v226
    v_and_b32 v41, 0xffff0000, v226
    v_lshlrev_b32 v42, 16, v227
    v_and_b32 v43, 0xffff0000, v227
    v_pk_add_f32 v[36:37], v[36:37], v[40:41]
    v_pk_add_f32 v[38:39], v[38:39], v[42:43]
    v_cvt_pk_bf16_f32 v204, v36, v37
    v_cvt_pk_bf16_f32 v205, v38, v39
    v_mov_b32 v64, v204
    v_mov_b32 v65, v205
    v_lshlrev_b32 v36, 16, v204
    v_and_b32 v37, 0xffff0000, v204
    v_lshlrev_b32 v38, 16, v205
    v_and_b32 v39, 0xffff0000, v205
    v_add_f32 v48, v48, v36
    v_fmac_f32 v49, v36, v36
    v_add_f32 v48, v48, v37
    v_fmac_f32 v49, v37, v37
    v_add_f32 v48, v48, v38
    v_fmac_f32 v49, v38, v38
    v_add_f32 v48, v48, v39
    v_fmac_f32 v49, v39, v39
    v_cvt_pk_bf16_f32 v40, v28, v29
    v_cvt_pk_bf16_f32 v41, v30, v31
    v_lshlrev_b32 v36, 16, v40
    v_and_b32 v37, 0xffff0000, v40
    v_lshlrev_b32 v38, 16, v41
    v_and_b32 v39, 0xffff0000, v41
    v_lshlrev_b32 v40, 16, v228
    v_and_b32 v41, 0xffff0000, v228
    v_lshlrev_b32 v42, 16, v229
    v_and_b32 v43, 0xffff0000, v229
    v_pk_add_f32 v[36:37], v[36:37], v[40:41]
    v_pk_add_f32 v[38:39], v[38:39], v[42:43]
    v_cvt_pk_bf16_f32 v206, v36, v37
    v_cvt_pk_bf16_f32 v207, v38, v39
    v_mov_b32 v66, v206
    v_mov_b32 v67, v207
    s_nop 1
    v_permlane16_swap_b32 v64, v66
    v_permlane16_swap_b32 v65, v67
    buffer_store_dwordx4 v[64:67], v234, s[48:51], 0 offen offset:1024 sc1
    v_lshlrev_b32 v36, 16, v206
    v_and_b32 v37, 0xffff0000, v206
    v_lshlrev_b32 v38, 16, v207
    v_and_b32 v39, 0xffff0000, v207
    v_add_f32 v48, v48, v36
    v_fmac_f32 v49, v36, v36
    v_add_f32 v48, v48, v37
    v_fmac_f32 v49, v37, v37
    v_add_f32 v48, v48, v38
    v_fmac_f32 v49, v38, v38
    v_add_f32 v48, v48, v39
    v_fmac_f32 v49, v39, v39
    v_cvt_pk_bf16_f32 v40, v32, v33
    v_cvt_pk_bf16_f32 v41, v34, v35
    v_lshlrev_b32 v36, 16, v40
    v_and_b32 v37, 0xffff0000, v40
    v_lshlrev_b32 v38, 16, v41
    v_and_b32 v39, 0xffff0000, v41
    v_lshlrev_b32 v40, 16, v230
    v_and_b32 v41, 0xffff0000, v230
    v_lshlrev_b32 v42, 16, v231
    v_and_b32 v43, 0xffff0000, v231
    v_pk_add_f32 v[36:37], v[36:37], v[40:41]
    v_pk_add_f32 v[38:39], v[38:39], v[42:43]
    v_cvt_pk_bf16_f32 v208, v36, v37
    v_cvt_pk_bf16_f32 v209, v38, v39
    v_mov_b32 v68, v208
    v_mov_b32 v69, v209
    v_lshlrev_b32 v36, 16, v208
    v_and_b32 v37, 0xffff0000, v208
    v_lshlrev_b32 v38, 16, v209
    v_and_b32 v39, 0xffff0000, v209
    v_add_f32 v48, v48, v36
    v_fmac_f32 v49, v36, v36
    v_add_f32 v48, v48, v37
    v_fmac_f32 v49, v37, v37
    v_add_f32 v48, v48, v38
    v_fmac_f32 v49, v38, v38
    v_add_f32 v48, v48, v39
    v_fmac_f32 v49, v39, v39
    buffer_store_dwordx2 v[68:69], v235, s[48:51], 0 offen offset:2048 sc1
    v_mov_b32 v36, v48
    v_mov_b32 v37, v48
    s_nop 1
    v_permlane32_swap_b32 v36, v37
    s_nop 0
    v_add_f32 v48, v36, v37
    v_mov_b32 v36, v49
    v_mov_b32 v37, v49
    s_nop 1
    v_permlane32_swap_b32 v36, v37
    s_nop 0
    v_add_f32 v49, v36, v37
    v_mov_b32 v36, v48
    v_mov_b32 v37, v48
    s_nop 1
    v_permlane16_swap_b32 v36, v37
    s_nop 0
    v_add_f32 v48, v36, v37
    v_mov_b32 v36, v49
    v_mov_b32 v37, v49
    s_nop 1
    v_permlane16_swap_b32 v36, v37
    s_nop 0
    v_add_f32 v49, v36, v37
    s_mov_b64 exec, 0xffff
    buffer_store_dwordx2 v[48:49], v221, s[60:63], 0 offen sc1
    s_mov_b64 exec, -1
    s_barrier
    s_lshr_b32 s5, s96, 1
    s_and_b32 s3, s96, 1
    s_and_b32 s6, s97, 7
    s_lshl_b32 s5, s5, 3
    s_add_u32 s77, s5, s6
    s_lshr_b32 s4, s97, 3
    s_lshl_b32 s3, s3, 2
    s_add_u32 s78, s3, s4
    s_lshl_b32 s64, s77, 6
    s_mul_i32 s65, s78, 80
    s_lshl_b32 s14, s77, 3
    s_add_u32 s14, s14, s78
    s_lshl_b32 s71, s78, 3
    s_add_u32 s64, s64, s71
    s_add_u32 s14, s14, 768
    s_add_u32 s48, s38, 11534336
    s_addc_u32 s49, s39, 0
    s_mov_b32 s50, 2621440
    s_mov_b32 s51, 0x00020000
    s_add_u32 s60, s38, 30408704
    s_addc_u32 s61, s39, 0
    s_mov_b32 s62, 8192
    s_mov_b32 s63, 0x00020000
    v_lshrrev_b32 v4, 5, v0
    v_and_b32 v14, 31, v0
    v_mul_u32_u24 v6, 40, v14
    v_mul_u32_u24 v8, 3840, v4
    v_add_u32 v8, v8, v6
    v_add_u32 v9, s64, v4
    s_waitcnt vmcnt(0)
    s_barrier
    ds_read_b64 v[16:17], v8 offset:53760
    ds_read_b64 v[18:19], v8 offset:53768
    ds_read_b64 v[20:21], v8 offset:53776
    ds_read_b64 v[22:23], v8 offset:53784
    ds_read_b64 v[24:25], v8 offset:53792
    ds_read_b64 v[32:33], v8 offset:55040
    ds_read_b64 v[34:35], v8 offset:55048
    ds_read_b64 v[36:37], v8 offset:55056
    ds_read_b64 v[38:39], v8 offset:55064
    ds_read_b64 v[40:41], v8 offset:55072
    ds_read_b64 v[42:43], v8 offset:47360
    ds_read_b64 v[44:45], v8 offset:47368
    ds_read_b64 v[46:47], v8 offset:47376
    ds_read_b64 v[48:49], v8 offset:47384
    ds_read_b64 v[50:51], v8 offset:47392
    v_mov_b32 v170, 0
    v_lshlrev_b32 v171, 16, v150
    v_and_b32 v172, 0xffff0000, v150
    v_lshlrev_b32 v173, 16, v160
    v_and_b32 v174, 0xffff0000, v160
    v_mul_f32 v171, v171, v173
    v_mul_f32 v172, v172, v174
    v_cvt_pk_bf16_f32 v171, v171, v172
    v_lshlrev_b32 v172, 16, v171
    v_and_b32 v173, 0xffff0000, v171
    v_add_f32 v170, v170, v172
    v_add_f32 v170, v170, v173
    v_lshlrev_b32 v171, 16, v151
    v_and_b32 v172, 0xffff0000, v151
    v_lshlrev_b32 v173, 16, v161
    v_and_b32 v174, 0xffff0000, v161
    v_mul_f32 v171, v171, v173
    v_mul_f32 v172, v172, v174
    v_cvt_pk_bf16_f32 v171, v171, v172
    v_lshlrev_b32 v172, 16, v171
    v_and_b32 v173, 0xffff0000, v171
    v_add_f32 v170, v170, v172
    v_add_f32 v170, v170, v173
    v_lshlrev_b32 v171, 16, v152
    v_and_b32 v172, 0xffff0000, v152
    v_lshlrev_b32 v173, 16, v162
    v_and_b32 v174, 0xffff0000, v162
    v_mul_f32 v171, v171, v173
    v_mul_f32 v172, v172, v174
    v_cvt_pk_bf16_f32 v171, v171, v172
    v_lshlrev_b32 v172, 16, v171
    v_and_b32 v173, 0xffff0000, v171
    v_add_f32 v170, v170, v172
    v_add_f32 v170, v170, v173
    v_lshlrev_b32 v171, 16, v153
    v_and_b32 v172, 0xffff0000, v153
    v_lshlrev_b32 v173, 16, v163
    v_and_b32 v174, 0xffff0000, v163
    v_mul_f32 v171, v171, v173
    v_mul_f32 v172, v172, v174
    v_cvt_pk_bf16_f32 v171, v171, v172
    v_lshlrev_b32 v172, 16, v171
    v_and_b32 v173, 0xffff0000, v171
    v_add_f32 v170, v170, v172
    v_add_f32 v170, v170, v173
    v_lshlrev_b32 v171, 16, v154
    v_and_b32 v172, 0xffff0000, v154
    v_lshlrev_b32 v173, 16, v164
    v_and_b32 v174, 0xffff0000, v164
    v_mul_f32 v171, v171, v173
    v_mul_f32 v172, v172, v174
    v_cvt_pk_bf16_f32 v171, v171, v172
    v_lshlrev_b32 v172, 16, v171
    v_and_b32 v173, 0xffff0000, v171
    v_add_f32 v170, v170, v172
    v_add_f32 v170, v170, v173
    v_lshlrev_b32 v171, 16, v155
    v_and_b32 v172, 0xffff0000, v155
    v_lshlrev_b32 v173, 16, v165
    v_and_b32 v174, 0xffff0000, v165
    v_mul_f32 v171, v171, v173
    v_mul_f32 v172, v172, v174
    v_cvt_pk_bf16_f32 v171, v171, v172
    v_lshlrev_b32 v172, 16, v171
    v_and_b32 v173, 0xffff0000, v171
    v_add_f32 v170, v170, v172
    v_add_f32 v170, v170, v173
    v_lshlrev_b32 v171, 16, v156
    v_and_b32 v172, 0xffff0000, v156
    v_lshlrev_b32 v173, 16, v166
    v_and_b32 v174, 0xffff0000, v166
    v_mul_f32 v171, v171, v173
    v_mul_f32 v172, v172, v174
    v_cvt_pk_bf16_f32 v171, v171, v172
    v_lshlrev_b32 v172, 16, v171
    v_and_b32 v173, 0xffff0000, v171
    v_add_f32 v170, v170, v172
    v_add_f32 v170, v170, v173
    v_lshlrev_b32 v171, 16, v157
    v_and_b32 v172, 0xffff0000, v157
    v_lshlrev_b32 v173, 16, v167
    v_and_b32 v174, 0xffff0000, v167
    v_mul_f32 v171, v171, v173
    v_mul_f32 v172, v172, v174
    v_cvt_pk_bf16_f32 v171, v171, v172
    v_lshlrev_b32 v172, 16, v171
    v_and_b32 v173, 0xffff0000, v171
    v_add_f32 v170, v170, v172
    v_add_f32 v170, v170, v173
    v_lshlrev_b32 v171, 16, v158
    v_and_b32 v172, 0xffff0000, v158
    v_lshlrev_b32 v173, 16, v168
    v_and_b32 v174, 0xffff0000, v168
    v_mul_f32 v171, v171, v173
    v_mul_f32 v172, v172, v174
    v_cvt_pk_bf16_f32 v171, v171, v172
    v_lshlrev_b32 v172, 16, v171
    v_and_b32 v173, 0xffff0000, v171
    v_add_f32 v170, v170, v172
    v_add_f32 v170, v170, v173
    v_lshlrev_b32 v171, 16, v159
    v_and_b32 v172, 0xffff0000, v159
    v_lshlrev_b32 v173, 16, v169
    v_and_b32 v174, 0xffff0000, v169
    v_mul_f32 v171, v171, v173
    v_mul_f32 v172, v172, v174
    v_cvt_pk_bf16_f32 v171, v171, v172
    v_lshlrev_b32 v172, 16, v171
    v_and_b32 v173, 0xffff0000, v171
    v_add_f32 v170, v170, v172
    v_add_f32 v170, v170, v173
    s_nop 1
    v_add_f32_dpp v170, v170, v170 row_ror:8 row_mask:0xf bank_mask:0xf
    s_nop 1
    v_add_f32_dpp v170, v170, v170 row_ror:4 row_mask:0xf bank_mask:0xf
    s_nop 1
    v_add_f32_dpp v170, v170, v170 row_ror:2 row_mask:0xf bank_mask:0xf
    s_nop 1
    v_add_f32_dpp v170, v170, v170 row_ror:1 row_mask:0xf bank_mask:0xf
    v_mov_b32 v171, v170
    v_mov_b32 v172, v170
    s_nop 1
    v_permlane16_swap_b32 v171, v172
    s_nop 0
    v_add_f32 v170, v171, v172
    v_cvt_pk_bf16_f32 v170, v170, v170
    v_lshlrev_b32 v170, 16, v170
    v_mul_f32 v170, 0xbfb8aa3b, v170
    v_exp_f32 v170, v170
    s_nop 0
    v_add_f32 v170, 1.0, v170
    v_rcp_f32 v170, v170
    s_nop 0
    v_cvt_pk_bf16_f32 v170, v170, v170
    v_lshlrev_b32 v170, 16, v170
    s_waitcnt lgkmcnt(0)
    ds_read_b64 v[52:53], v8 offset:39680
    ds_read_b64 v[54:55], v8 offset:39688
    ds_read_b64 v[56:57], v8 offset:39696
    ds_read_b64 v[58:59], v8 offset:39704
    ds_read_b64 v[60:61], v8 offset:39712
    ds_read_b64 v[62:63], v8 offset:32000
    ds_read_b64 v[64:65], v8 offset:32008
    ds_read_b64 v[66:67], v8 offset:32016
    ds_read_b64 v[68:69], v8 offset:32024
    ds_read_b64 v[70:71], v8 offset:32032
    v_mov_b32 v112, 0
    v_dot2_f32_bf16 v112, v16, v32, v112
    v_dot2_f32_bf16 v112, v17, v33, v112
    v_dot2_f32_bf16 v112, v18, v34, v112
    v_dot2_f32_bf16 v112, v19, v35, v112
    v_dot2_f32_bf16 v112, v20, v36, v112
    v_dot2_f32_bf16 v112, v21, v37, v112
    v_dot2_f32_bf16 v112, v22, v38, v112
    v_dot2_f32_bf16 v112, v23, v39, v112
    v_dot2_f32_bf16 v112, v24, v40, v112
    v_dot2_f32_bf16 v112, v25, v41, v112
    v_mov_b32 v113, 0
    v_dot2_f32_bf16 v113, v16, v42, v113
    v_dot2_f32_bf16 v113, v17, v43, v113
    v_dot2_f32_bf16 v113, v18, v44, v113
    v_dot2_f32_bf16 v113, v19, v45, v113
    v_dot2_f32_bf16 v113, v20, v46, v113
    v_dot2_f32_bf16 v113, v21, v47, v113
    v_dot2_f32_bf16 v113, v22, v48, v113
    v_dot2_f32_bf16 v113, v23, v49, v113
    v_dot2_f32_bf16 v113, v24, v50, v113
    v_dot2_f32_bf16 v113, v25, v51, v113
    s_waitcnt lgkmcnt(0)
    ds_read_b64 v[72:73], v8 offset:24320
    ds_read_b64 v[74:75], v8 offset:24328
    ds_read_b64 v[76:77], v8 offset:24336
    ds_read_b64 v[78:79], v8 offset:24344
    ds_read_b64 v[80:81], v8 offset:24352
    ds_read_b64 v[82:83], v8 offset:16640
    ds_read_b64 v[84:85], v8 offset:16648
    ds_read_b64 v[86:87], v8 offset:16656
    ds_read_b64 v[88:89], v8 offset:16664
    ds_read_b64 v[90:91], v8 offset:16672
    v_mov_b32 v114, 0
    v_dot2_f32_bf16 v114, v16, v52, v114
    v_dot2_f32_bf16 v114, v17, v53, v114
    v_dot2_f32_bf16 v114, v18, v54, v114
    v_dot2_f32_bf16 v114, v19, v55, v114
    v_dot2_f32_bf16 v114, v20, v56, v114
    v_dot2_f32_bf16 v114, v21, v57, v114
    v_dot2_f32_bf16 v114, v22, v58, v114
    v_dot2_f32_bf16 v114, v23, v59, v114
    v_dot2_f32_bf16 v114, v24, v60, v114
    v_dot2_f32_bf16 v114, v25, v61, v114
    v_mov_b32 v115, 0
    v_dot2_f32_bf16 v115, v16, v62, v115
    v_dot2_f32_bf16 v115, v17, v63, v115
    v_dot2_f32_bf16 v115, v18, v64, v115
    v_dot2_f32_bf16 v115, v19, v65, v115
    v_dot2_f32_bf16 v115, v20, v66, v115
    v_dot2_f32_bf16 v115, v21, v67, v115
    v_dot2_f32_bf16 v115, v22, v68, v115
    v_dot2_f32_bf16 v115, v23, v69, v115
    v_dot2_f32_bf16 v115, v24, v70, v115
    v_dot2_f32_bf16 v115, v25, v71, v115
    s_waitcnt lgkmcnt(0)
    ds_read_b64 v[92:93], v8 offset:8960
    ds_read_b64 v[94:95], v8 offset:8968
    ds_read_b64 v[96:97], v8 offset:8976
    ds_read_b64 v[98:99], v8 offset:8984
    ds_read_b64 v[100:101], v8 offset:8992
    ds_read_b64 v[102:103], v8 offset:1280
    ds_read_b64 v[104:105], v8 offset:1288
    ds_read_b64 v[106:107], v8 offset:1296
    ds_read_b64 v[108:109], v8 offset:1304
    ds_read_b64 v[110:111], v8 offset:1312
    v_mov_b32 v116, 0
    v_dot2_f32_bf16 v116, v16, v72, v116
    v_dot2_f32_bf16 v116, v17, v73, v116
    v_dot2_f32_bf16 v116, v18, v74, v116
    v_dot2_f32_bf16 v116, v19, v75, v116
    v_dot2_f32_bf16 v116, v20, v76, v116
    v_dot2_f32_bf16 v116, v21, v77, v116
    v_dot2_f32_bf16 v116, v22, v78, v116
    v_dot2_f32_bf16 v116, v23, v79, v116
    v_dot2_f32_bf16 v116, v24, v80, v116
    v_dot2_f32_bf16 v116, v25, v81, v116
    v_mov_b32 v117, 0
    v_dot2_f32_bf16 v117, v16, v82, v117
    v_dot2_f32_bf16 v117, v17, v83, v117
    v_dot2_f32_bf16 v117, v18, v84, v117
    v_dot2_f32_bf16 v117, v19, v85, v117
    v_dot2_f32_bf16 v117, v20, v86, v117
    v_dot2_f32_bf16 v117, v21, v87, v117
    v_dot2_f32_bf16 v117, v22, v88, v117
    v_dot2_f32_bf16 v117, v23, v89, v117
    v_dot2_f32_bf16 v117, v24, v90, v117
    v_dot2_f32_bf16 v117, v25, v91, v117
    s_waitcnt lgkmcnt(0)
    v_mov_b32 v118, 0
    v_dot2_f32_bf16 v118, v16, v92, v118
    v_dot2_f32_bf16 v118, v17, v93, v118
    v_dot2_f32_bf16 v118, v18, v94, v118
    v_dot2_f32_bf16 v118, v19, v95, v118
    v_dot2_f32_bf16 v118, v20, v96, v118
    v_dot2_f32_bf16 v118, v21, v97, v118
    v_dot2_f32_bf16 v118, v22, v98, v118
    v_dot2_f32_bf16 v118, v23, v99, v118
    v_dot2_f32_bf16 v118, v24, v100, v118
    v_dot2_f32_bf16 v118, v25, v101, v118
    v_mov_b32 v119, 0
    v_dot2_f32_bf16 v119, v16, v102, v119
    v_dot2_f32_bf16 v119, v17, v103, v119
    v_dot2_f32_bf16 v119, v18, v104, v119
    v_dot2_f32_bf16 v119, v19, v105, v119
    v_dot2_f32_bf16 v119, v20, v106, v119
    v_dot2_f32_bf16 v119, v21, v107, v119
    v_dot2_f32_bf16 v119, v22, v108, v119
    v_dot2_f32_bf16 v119, v23, v109, v119
    v_dot2_f32_bf16 v119, v24, v110, v119
    v_dot2_f32_bf16 v119, v25, v111, v119
    s_nop 3
    ds_read_b64 v[32:33], v8 offset:56320
    ds_read_b64 v[34:35], v8 offset:56328
    ds_read_b64 v[36:37], v8 offset:56336
    ds_read_b64 v[38:39], v8 offset:56344
    ds_read_b64 v[40:41], v8 offset:56352
    ds_read_b64 v[42:43], v8 offset:48640
    ds_read_b64 v[44:45], v8 offset:48648
    ds_read_b64 v[46:47], v8 offset:48656
    ds_read_b64 v[48:49], v8 offset:48664
    ds_read_b64 v[50:51], v8 offset:48672
    ds_read_b64 v[52:53], v8 offset:40960
    ds_read_b64 v[54:55], v8 offset:40968
    ds_read_b64 v[56:57], v8 offset:40976
    ds_read_b64 v[58:59], v8 offset:40984
    ds_read_b64 v[60:61], v8 offset:40992
    s_mov_b32 s88, 0x3e64f92e
    v_mov_b32 v10, 0xce6e0000
    v_cvt_pk_bf16_f32 v112, v112, v112
    v_lshlrev_b32 v112, 16, v112
    v_mul_f32 v112, s88, v112
    v_cvt_pk_bf16_f32 v112, v112, v112
    v_lshlrev_b32 v112, 16, v112
    v_cvt_pk_bf16_f32 v113, v113, v113
    v_lshlrev_b32 v113, 16, v113
    v_mul_f32 v113, s88, v113
    v_cvt_pk_bf16_f32 v113, v113, v113
    v_lshlrev_b32 v113, 16, v113
    v_cmp_gt_u32 vcc, 2, v9
    s_nop 1
    v_cndmask_b32 v113, v113, v10, vcc
    v_cvt_pk_bf16_f32 v114, v114, v114
    v_lshlrev_b32 v114, 16, v114
    v_mul_f32 v114, s88, v114
    v_cvt_pk_bf16_f32 v114, v114, v114
    v_lshlrev_b32 v114, 16, v114
    v_cmp_gt_u32 vcc, 4, v9
    s_nop 1
    v_cndmask_b32 v114, v114, v10, vcc
    v_cvt_pk_bf16_f32 v115, v115, v115
    v_lshlrev_b32 v115, 16, v115
    v_mul_f32 v115, s88, v115
    v_cvt_pk_bf16_f32 v115, v115, v115
    v_lshlrev_b32 v115, 16, v115
    v_cmp_gt_u32 vcc, 6, v9
    s_nop 1
    v_cndmask_b32 v115, v115, v10, vcc
    v_cvt_pk_bf16_f32 v116, v116, v116
    v_lshlrev_b32 v116, 16, v116
    v_mul_f32 v116, s88, v116
    v_cvt_pk_bf16_f32 v116, v116, v116
    v_lshlrev_b32 v116, 16, v116
    v_cmp_gt_u32 vcc, 8, v9
    s_nop 1
    v_cndmask_b32 v116, v116, v10, vcc
    v_cvt_pk_bf16_f32 v117, v117, v117
    v_lshlrev_b32 v117, 16, v117
    v_mul_f32 v117, s88, v117
    v_cvt_pk_bf16_f32 v117, v117, v117
    v_lshlrev_b32 v117, 16, v117
    v_cmp_gt_u32 vcc, 10, v9
    s_nop 1
    v_cndmask_b32 v117, v117, v10, vcc
    v_cvt_pk_bf16_f32 v118, v118, v118
    v_lshlrev_b32 v118, 16, v118
    v_mul_f32 v118, s88, v118
    v_cvt_pk_bf16_f32 v118, v118, v118
    v_lshlrev_b32 v118, 16, v118
    v_cmp_gt_u32 vcc, 12, v9
    s_nop 1
    v_cndmask_b32 v118, v118, v10, vcc
    v_cvt_pk_bf16_f32 v119, v119, v119
    v_lshlrev_b32 v119, 16, v119
    v_mul_f32 v119, s88, v119
    v_cvt_pk_bf16_f32 v119, v119, v119
    v_lshlrev_b32 v119, 16, v119
    v_cmp_gt_u32 vcc, 14, v9
    s_nop 1
    v_cndmask_b32 v119, v119, v10, vcc
    v_max3_f32 v11, v112, v113, v114
    v_max3_f32 v11, v11, v115, v116
    v_max3_f32 v11, v11, v117, v118
    v_max_f32 v11, v11, v119
    s_mov_b32 s89, 0x3fb8aa3b
    v_sub_f32 v112, v112, v11
    v_mul_f32 v112, s89, v112
    v_exp_f32 v112, v112
    v_sub_f32 v113, v113, v11
    v_mul_f32 v113, s89, v113
    v_exp_f32 v113, v113
    v_sub_f32 v114, v114, v11
    v_mul_f32 v114, s89, v114
    v_exp_f32 v114, v114
    v_sub_f32 v115, v115, v11
    v_mul_f32 v115, s89, v115
    v_exp_f32 v115, v115
    v_sub_f32 v116, v116, v11
    v_mul_f32 v116, s89, v116
    v_exp_f32 v116, v116
    v_sub_f32 v117, v117, v11
    v_mul_f32 v117, s89, v117
    v_exp_f32 v117, v117
    v_sub_f32 v118, v118, v11
    v_mul_f32 v118, s89, v118
    v_exp_f32 v118, v118
    v_sub_f32 v119, v119, v11
    v_mul_f32 v119, s89, v119
    v_exp_f32 v119, v119
    s_waitcnt lgkmcnt(0)
    ds_read_b64 v[62:63], v8 offset:33280
    ds_read_b64 v[64:65], v8 offset:33288
    ds_read_b64 v[66:67], v8 offset:33296
    ds_read_b64 v[68:69], v8 offset:33304
    ds_read_b64 v[70:71], v8 offset:33312
    ds_read_b64 v[72:73], v8 offset:25600
    ds_read_b64 v[74:75], v8 offset:25608
    ds_read_b64 v[76:77], v8 offset:25616
    ds_read_b64 v[78:79], v8 offset:25624
    ds_read_b64 v[80:81], v8 offset:25632
    ds_read_b64 v[82:83], v8 offset:17920
    ds_read_b64 v[84:85], v8 offset:17928
    ds_read_b64 v[86:87], v8 offset:17936
    ds_read_b64 v[88:89], v8 offset:17944
    ds_read_b64 v[90:91], v8 offset:17952
    v_add_f32 v12, v112, v113
    v_add_f32 v12, v12, v114
    v_add_f32 v12, v12, v115
    v_add_f32 v12, v12, v116
    v_add_f32 v12, v12, v117
    v_add_f32 v12, v12, v118
    v_add_f32 v12, v12, v119
    v_rcp_f32 v12, v12
    s_nop 0
    v_mul_f32 v112, v112, v12
    v_mul_f32 v113, v113, v12
    v_mul_f32 v114, v114, v12
    v_mul_f32 v115, v115, v12
    v_mul_f32 v116, v116, v12
    v_mul_f32 v117, v117, v12
    v_mul_f32 v118, v118, v12
    v_mul_f32 v119, v119, v12
    v_cvt_pk_bf16_f32 v120, v112, v113
    v_cvt_pk_bf16_f32 v121, v114, v115
    v_cvt_pk_bf16_f32 v122, v116, v117
    v_cvt_pk_bf16_f32 v123, v118, v119
    s_waitcnt lgkmcnt(0)
    ds_read_b64 v[92:93], v8 offset:10240
    ds_read_b64 v[94:95], v8 offset:10248
    ds_read_b64 v[96:97], v8 offset:10256
    ds_read_b64 v[98:99], v8 offset:10264
    ds_read_b64 v[100:101], v8 offset:10272
    ds_read_b64 v[102:103], v8 offset:2560
    ds_read_b64 v[104:105], v8 offset:2568
    ds_read_b64 v[106:107], v8 offset:2576
    ds_read_b64 v[108:109], v8 offset:2584
    ds_read_b64 v[110:111], v8 offset:2592
    s_mov_b32 s90, 0x05040100
    s_mov_b32 s91, 0x07060302
    v_mov_b32 v124, 0
    v_mov_b32 v125, 0
    v_mov_b32 v126, 0
    v_mov_b32 v127, 0
    v_mov_b32 v128, 0
    v_mov_b32 v129, 0
    v_mov_b32 v130, 0
    v_mov_b32 v131, 0
    v_mov_b32 v132, 0
    v_mov_b32 v133, 0
    v_mov_b32 v134, 0
    v_mov_b32 v135, 0
    v_mov_b32 v136, 0
    v_mov_b32 v137, 0
    v_mov_b32 v138, 0
    v_mov_b32 v139, 0
    v_mov_b32 v140, 0
    v_mov_b32 v141, 0
    v_mov_b32 v142, 0
    v_mov_b32 v143, 0
    v_perm_b32 v16, v42, v32, s90
    v_perm_b32 v17, v42, v32, s91
    v_dot2_f32_bf16 v124, v16, v120, v124
    v_dot2_f32_bf16 v125, v17, v120, v125
    v_perm_b32 v18, v43, v33, s90
    v_perm_b32 v19, v43, v33, s91
    v_dot2_f32_bf16 v126, v18, v120, v126
    v_dot2_f32_bf16 v127, v19, v120, v127
    v_perm_b32 v16, v44, v34, s90
    v_perm_b32 v17, v44, v34, s91
    v_dot2_f32_bf16 v128, v16, v120, v128
    v_dot2_f32_bf16 v129, v17, v120, v129
    v_perm_b32 v18, v45, v35, s90
    v_perm_b32 v19, v45, v35, s91
    v_dot2_f32_bf16 v130, v18, v120, v130
    v_dot2_f32_bf16 v131, v19, v120, v131
    v_perm_b32 v16, v46, v36, s90
    v_perm_b32 v17, v46, v36, s91
    v_dot2_f32_bf16 v132, v16, v120, v132
    v_dot2_f32_bf16 v133, v17, v120, v133
    v_perm_b32 v18, v47, v37, s90
    v_perm_b32 v19, v47, v37, s91
    v_dot2_f32_bf16 v134, v18, v120, v134
    v_dot2_f32_bf16 v135, v19, v120, v135
    v_perm_b32 v16, v48, v38, s90
    v_perm_b32 v17, v48, v38, s91
    v_dot2_f32_bf16 v136, v16, v120, v136
    v_dot2_f32_bf16 v137, v17, v120, v137
    v_perm_b32 v18, v49, v39, s90
    v_perm_b32 v19, v49, v39, s91
    v_dot2_f32_bf16 v138, v18, v120, v138
    v_dot2_f32_bf16 v139, v19, v120, v139
    v_perm_b32 v16, v50, v40, s90
    v_perm_b32 v17, v50, v40, s91
    v_dot2_f32_bf16 v140, v16, v120, v140
    v_dot2_f32_bf16 v141, v17, v120, v141
    v_perm_b32 v18, v51, v41, s90
    v_perm_b32 v19, v51, v41, s91
    v_dot2_f32_bf16 v142, v18, v120, v142
    v_dot2_f32_bf16 v143, v19, v120, v143
    v_perm_b32 v16, v62, v52, s90
    v_perm_b32 v17, v62, v52, s91
    v_dot2_f32_bf16 v124, v16, v121, v124
    v_dot2_f32_bf16 v125, v17, v121, v125
    v_perm_b32 v18, v63, v53, s90
    v_perm_b32 v19, v63, v53, s91
    v_dot2_f32_bf16 v126, v18, v121, v126
    v_dot2_f32_bf16 v127, v19, v121, v127
    v_perm_b32 v16, v64, v54, s90
    v_perm_b32 v17, v64, v54, s91
    v_dot2_f32_bf16 v128, v16, v121, v128
    v_dot2_f32_bf16 v129, v17, v121, v129
    v_perm_b32 v18, v65, v55, s90
    v_perm_b32 v19, v65, v55, s91
    v_dot2_f32_bf16 v130, v18, v121, v130
    v_dot2_f32_bf16 v131, v19, v121, v131
    v_perm_b32 v16, v66, v56, s90
    v_perm_b32 v17, v66, v56, s91
    v_dot2_f32_bf16 v132, v16, v121, v132
    v_dot2_f32_bf16 v133, v17, v121, v133
    v_perm_b32 v18, v67, v57, s90
    v_perm_b32 v19, v67, v57, s91
    v_dot2_f32_bf16 v134, v18, v121, v134
    v_dot2_f32_bf16 v135, v19, v121, v135
    v_perm_b32 v16, v68, v58, s90
    v_perm_b32 v17, v68, v58, s91
    v_dot2_f32_bf16 v136, v16, v121, v136
    v_dot2_f32_bf16 v137, v17, v121, v137
    v_perm_b32 v18, v69, v59, s90
    v_perm_b32 v19, v69, v59, s91
    v_dot2_f32_bf16 v138, v18, v121, v138
    v_dot2_f32_bf16 v139, v19, v121, v139
    v_perm_b32 v16, v70, v60, s90
    v_perm_b32 v17, v70, v60, s91
    v_dot2_f32_bf16 v140, v16, v121, v140
    v_dot2_f32_bf16 v141, v17, v121, v141
    v_perm_b32 v18, v71, v61, s90
    v_perm_b32 v19, v71, v61, s91
    v_dot2_f32_bf16 v142, v18, v121, v142
    v_dot2_f32_bf16 v143, v19, v121, v143
    v_perm_b32 v16, v82, v72, s90
    v_perm_b32 v17, v82, v72, s91
    v_dot2_f32_bf16 v124, v16, v122, v124
    v_dot2_f32_bf16 v125, v17, v122, v125
    v_perm_b32 v18, v83, v73, s90
    v_perm_b32 v19, v83, v73, s91
    v_dot2_f32_bf16 v126, v18, v122, v126
    v_dot2_f32_bf16 v127, v19, v122, v127
    v_perm_b32 v16, v84, v74, s90
    v_perm_b32 v17, v84, v74, s91
    v_dot2_f32_bf16 v128, v16, v122, v128
    v_dot2_f32_bf16 v129, v17, v122, v129
    v_perm_b32 v18, v85, v75, s90
    v_perm_b32 v19, v85, v75, s91
    v_dot2_f32_bf16 v130, v18, v122, v130
    v_dot2_f32_bf16 v131, v19, v122, v131
    v_perm_b32 v16, v86, v76, s90
    v_perm_b32 v17, v86, v76, s91
    v_dot2_f32_bf16 v132, v16, v122, v132
    v_dot2_f32_bf16 v133, v17, v122, v133
    v_perm_b32 v18, v87, v77, s90
    v_perm_b32 v19, v87, v77, s91
    v_dot2_f32_bf16 v134, v18, v122, v134
    v_dot2_f32_bf16 v135, v19, v122, v135
    v_perm_b32 v16, v88, v78, s90
    v_perm_b32 v17, v88, v78, s91
    v_dot2_f32_bf16 v136, v16, v122, v136
    v_dot2_f32_bf16 v137, v17, v122, v137
    v_perm_b32 v18, v89, v79, s90
    v_perm_b32 v19, v89, v79, s91
    v_dot2_f32_bf16 v138, v18, v122, v138
    v_dot2_f32_bf16 v139, v19, v122, v139
    v_perm_b32 v16, v90, v80, s90
    v_perm_b32 v17, v90, v80, s91
    v_dot2_f32_bf16 v140, v16, v122, v140
    v_dot2_f32_bf16 v141, v17, v122, v141
    v_perm_b32 v18, v91, v81, s90
    v_perm_b32 v19, v91, v81, s91
    v_dot2_f32_bf16 v142, v18, v122, v142
    v_dot2_f32_bf16 v143, v19, v122, v143
    s_waitcnt lgkmcnt(0)
    v_perm_b32 v16, v102, v92, s90
    v_perm_b32 v17, v102, v92, s91
    v_dot2_f32_bf16 v124, v16, v123, v124
    v_dot2_f32_bf16 v125, v17, v123, v125
    v_perm_b32 v18, v103, v93, s90
    v_perm_b32 v19, v103, v93, s91
    v_dot2_f32_bf16 v126, v18, v123, v126
    v_dot2_f32_bf16 v127, v19, v123, v127
    v_perm_b32 v16, v104, v94, s90
    v_perm_b32 v17, v104, v94, s91
    v_dot2_f32_bf16 v128, v16, v123, v128
    v_dot2_f32_bf16 v129, v17, v123, v129
    v_perm_b32 v18, v105, v95, s90
    v_perm_b32 v19, v105, v95, s91
    v_dot2_f32_bf16 v130, v18, v123, v130
    v_dot2_f32_bf16 v131, v19, v123, v131
    v_perm_b32 v16, v106, v96, s90
    v_perm_b32 v17, v106, v96, s91
    v_dot2_f32_bf16 v132, v16, v123, v132
    v_dot2_f32_bf16 v133, v17, v123, v133
    v_perm_b32 v18, v107, v97, s90
    v_perm_b32 v19, v107, v97, s91
    v_dot2_f32_bf16 v134, v18, v123, v134
    v_dot2_f32_bf16 v135, v19, v123, v135
    v_perm_b32 v16, v108, v98, s90
    v_perm_b32 v17, v108, v98, s91
    v_dot2_f32_bf16 v136, v16, v123, v136
    v_dot2_f32_bf16 v137, v17, v123, v137
    v_perm_b32 v18, v109, v99, s90
    v_perm_b32 v19, v109, v99, s91
    v_dot2_f32_bf16 v138, v18, v123, v138
    v_dot2_f32_bf16 v139, v19, v123, v139
    v_perm_b32 v16, v110, v100, s90
    v_perm_b32 v17, v110, v100, s91
    v_dot2_f32_bf16 v140, v16, v123, v140
    v_dot2_f32_bf16 v141, v17, v123, v141
    v_perm_b32 v18, v111, v101, s90
    v_perm_b32 v19, v111, v101, s91
    v_dot2_f32_bf16 v142, v18, v123, v142
    v_dot2_f32_bf16 v143, v19, v123, v143
    s_nop 3
    v_cvt_pk_bf16_f32 v32, v124, v125
    v_cvt_pk_bf16_f32 v33, v126, v127
    v_cvt_pk_bf16_f32 v34, v128, v129
    v_cvt_pk_bf16_f32 v35, v130, v131
    v_cvt_pk_bf16_f32 v36, v132, v133
    v_cvt_pk_bf16_f32 v37, v134, v135
    v_cvt_pk_bf16_f32 v38, v136, v137
    v_cvt_pk_bf16_f32 v39, v138, v139
    v_cvt_pk_bf16_f32 v40, v140, v141
    v_cvt_pk_bf16_f32 v41, v142, v143
    v_lshrrev_b32 v4, 5, v0
    v_mul_u32_u24 v4, 1296, v4
    v_add3_u32 v4, v4, v6, 0
    v_add_u32 v4, 86016, v4
    ds_write_b64 v4, v[32:33] offset:0
    ds_write_b64 v4, v[34:35] offset:8
    ds_write_b64 v4, v[36:37] offset:16
    ds_write_b64 v4, v[38:39] offset:24
    ds_write_b64 v4, v[40:41] offset:32
    v_and_b32 v6, 7, v0
    v_lshrrev_b32 v7, 3, v0
    v_mul_u32_u24 v5, 1296, v6
    v_lshl_add_u32 v5, v7, 4, v5
    v_add_u32 v5, 86016, v5
    v_lshlrev_b32 v6, 4, v6
    v_lshl_add_u32 v6, v7, 8, v6
    s_lshr_b32 s73, s64, 4
    s_mul_i32 s73, s73, 20480
    s_and_b32 s72, s64, 15
    s_lshl_b32 s72, s72, 4
    s_add_u32 s72, s72, s73
    s_waitcnt lgkmcnt(0)
    s_barrier
    ds_read_b128 v[16:19], v5 offset:0
    ds_read_b128 v[20:23], v5 offset:512
    ds_read_b128 v[24:27], v5 offset:1024
    s_waitcnt lgkmcnt(2)
    buffer_store_dwordx4 v[16:19], v6, s[48:51], s72 offen sc1
    s_add_u32 s72, s72, 8192
    s_waitcnt lgkmcnt(1)
    buffer_store_dwordx4 v[20:23], v6, s[48:51], s72 offen sc1
    s_add_u32 s72, s72, 8192
    s_waitcnt lgkmcnt(0)
    s_cmp_ge_u32 s66, 2
    s_cbranch_scc1 Lsk_11
    buffer_store_dwordx4 v[24:27], v6, s[48:51], s72 offen sc1
    s_add_u32 s72, s72, 8192
Lsk_11:
    s_mov_b32 s92, s38
    s_mov_b32 s93, s39
    s_mov_b32 s94, 41943040
    s_mov_b32 s95, 0x00020000
    buffer_store_dwordx4 v[176:179], v188, s[92:95], 0 offen sc1
    buffer_store_dwordx4 v[180:183], v189, s[92:95], 0 offen sc1
    buffer_store_dwordx4 v[184:187], v190, s[92:95], 0 offen sc1
    v_lshlrev_b32 v171, 2, v9
    v_cmp_eq_u32 vcc, 0, v14
    s_nop 1
    s_mov_b64 exec, vcc
    buffer_store_dword v170, v171, s[60:63], 0 offen sc1
    s_mov_b64 exec, -1
    s_lshr_b32 s5, s96, 1
    s_and_b32 s3, s96, 1
    s_and_b32 s6, s97, 3
    s_lshl_b32 s5, s5, 2
    s_add_u32 s77, s5, s6
    s_lshr_b32 s4, s97, 2
    s_lshl_b32 s3, s3, 3
    s_add_u32 s78, s3, s4
    s_lshl_b32 s64, s77, 7
    s_mul_i32 s65, s78, 27
    s_lshr_b32 s65, s65, 1
    s_lshl_b32 s65, s65, 3
    s_lshl_b32 s14, s77, 4
    s_add_u32 s14, s14, s78
    s_add_u32 s14, s14, 1024
    s_add_u32 s48, s38, 20971520
    s_addc_u32 s49, s39, 0
    s_mov_b32 s50, 7077888
    s_mov_b32 s51, 0x00020000
    s_add_u32 s60, s38, 29360128
    s_addc_u32 s61, s39, 0
    s_mov_b32 s62, 262144
    s_mov_b32 s63, 0x00020000
    s_mul_i32 s71, s66, 32
    s_add_u32 s71, s71, s64
    v_and_b32 v4, 15, v1
    v_add_u32 v4, s71, v4
    v_lshrrev_b32 v5, 4, v4
    v_mul_u32_u24 v5, 55296, v5
    v_and_b32 v4, 15, v4
    v_lshl_add_u32 v5, v4, 4, v5
    s_lshl_b32 s72, s65, 5
    v_add_u32 v5, s72, v5
    v_lshrrev_b32 v6, 4, v1
    v_and_b32 v7, 1, v6
    v_lshrrev_b32 v6, 1, v6
    v_lshl_add_u32 v4, v6, 8, v5
    v_lshl_add_u32 v234, v7, 9, v4
    v_lshl_add_u32 v235, v7, 3, v4
    v_mov_b32 v242, v4
    v_mov_b32 v243, v7
    v_and_b32 v2, 15, v1
    v_lshrrev_b32 v3, 4, v1
    s_mov_b32 s71, s66
    s_mov_b32 s72, 0
    v_lshlrev_b32 v4, 4, v1
    s_mul_i32 s73, s71, 4096
    s_add_u32 s73, s73, 98304
    v_add_u32 v8, s73, v4
    v_lshrrev_b32 v4, 2, v2
    v_and_b32 v5, 1, v3
    v_lshl_add_u32 v4, v5, 2, v4
    v_lshrrev_b32 v5, 1, v3
    v_lshl_add_u32 v4, v5, 4, v4
    v_mul_u32_u24 v4, 224, v4
    v_and_b32 v5, 3, v2
    v_lshl_add_u32 v4, v5, 3, v4
    v_add_u32 v244, 114688, v4
    v_mov_b32 v4, v244
    s_mul_i32 s73, s66, 2
    s_add_u32 s73, s73, 0
    s_cmp_ge_u32 s73, 7
    s_cselect_b32 s91, 7, 0
    s_sub_u32 s73, s73, s91
    s_lshl_b32 s73, s73, 5
    v_add_u32 v244, s73, v4
    s_mul_i32 s73, s66, 2
    s_add_u32 s73, s73, 1
    s_cmp_ge_u32 s73, 7
    s_cselect_b32 s91, 7, 0
    s_sub_u32 s73, s73, s91
    s_lshl_b32 s73, s73, 5
    v_add_u32 v245, s73, v4
    s_mul_i32 s73, s66, 2
    s_add_u32 s73, s73, 2
    s_cmp_ge_u32 s73, 7
    s_cselect_b32 s91, 7, 0
    s_sub_u32 s73, s73, s91
    s_lshl_b32 s73, s73, 5
    v_add_u32 v246, s73, v4
    s_mul_i32 s73, s66, 2
    s_add_u32 s73, s73, 3
    s_cmp_ge_u32 s73, 7
    s_cselect_b32 s91, 7, 0
    s_sub_u32 s73, s73, s91
    s_lshl_b32 s73, s73, 5
    v_add_u32 v247, s73, v4
    s_mul_i32 s73, s66, 2
    s_add_u32 s73, s73, 4
    s_cmp_ge_u32 s73, 7
    s_cselect_b32 s91, 7, 0
    s_sub_u32 s73, s73, s91
    s_lshl_b32 s73, s73, 5
    v_add_u32 v248, s73, v4
    s_mul_i32 s73, s66, 2
    s_add_u32 s73, s73, 5
    s_cmp_ge_u32 s73, 7
    s_cselect_b32 s91, 7, 0
    s_sub_u32 s73, s73, s91
    s_lshl_b32 s73, s73, 5
    v_add_u32 v249, s73, v4
    s_mul_i32 s73, s66, 2
    s_add_u32 s73, s73, 6
    s_cmp_ge_u32 s73, 7
    s_cselect_b32 s91, 7, 0
    s_sub_u32 s73, s73, s91
    s_lshl_b32 s73, s73, 5
    v_add_u32 v250, s73, v4
    s_mul_i32 s73, s66, 7680
    s_add_u32 s73, s73, 98304
    v_mul_u32_u24 v4, 240, v2
    v_lshl_add_u32 v4, v3, 3, v4
    v_add_u32 v12, s73, v4
    v_mov_b32 v16, 0
    v_mov_b32 v17, 0
    v_mov_b32 v18, 0
    v_mov_b32 v19, 0
    v_mov_b32 v20, 0
    v_mov_b32 v21, 0
    v_mov_b32 v22, 0
    v_mov_b32 v23, 0
    v_mov_b32 v24, 0
    v_mov_b32 v25, 0
    v_mov_b32 v26, 0
    v_mov_b32 v27, 0
    v_mov_b32 v28, 0
    v_mov_b32 v29, 0
    v_mov_b32 v30, 0
    v_mov_b32 v31, 0
    v_mov_b32 v32, 0
    v_mov_b32 v33, 0
    v_mov_b32 v34, 0
    v_mov_b32 v35, 0
    v_mov_b32 v36, 0
    v_mov_b32 v37, 0
    v_mov_b32 v38, 0
    v_mov_b32 v39, 0
    v_mov_b32 v40, 0
    v_mov_b32 v41, 0
    v_mov_b32 v42, 0
    v_mov_b32 v43, 0
    v_mov_b32 v44, 0
    v_mov_b32 v45, 0
    v_mov_b32 v46, 0
    v_mov_b32 v47, 0
    v_mov_b32 v48, 0
    v_mov_b32 v49, 0
    v_mov_b32 v50, 0
    v_mov_b32 v51, 0
    v_mov_b32 v52, 0
    v_mov_b32 v53, 0
    v_mov_b32 v54, 0
    v_mov_b32 v55, 0
    v_mov_b32 v56, 0
    v_mov_b32 v57, 0
    v_mov_b32 v58, 0
    v_mov_b32 v59, 0
    v_mov_b32 v60, 0
    v_mov_b32 v61, 0
    v_mov_b32 v62, 0
    v_mov_b32 v63, 0
    v_mov_b32 v64, 0
    v_mov_b32 v65, 0
    v_mov_b32 v66, 0
    v_mov_b32 v67, 0
    v_mov_b32 v68, 0
    v_mov_b32 v69, 0
    v_mov_b32 v70, 0
    v_mov_b32 v71, 0
    v_mov_b32 v144, 0
    v_mov_b32 v145, 0
    v_mov_b32 v146, 0
    v_mov_b32 v147, 0
    v_mov_b32 v148, 0
    v_mov_b32 v149, 0
    v_mov_b32 v150, 0
    v_mov_b32 v151, 0
    v_mov_b32 v152, 0x3f803f80
    v_mov_b32 v153, 0x3f803f80
    v_mov_b32 v154, 0x3f803f80
    v_mov_b32 v155, 0x3f803f80
    s_mov_b32 s69, 98304
    s_barrier
    ds_read_b128 v[72:75], v8 offset:0
    ds_read_b128 v[76:79], v8 offset:2048
    ds_read_b64_tr_b16 v[80:81], v244 offset:0
    ds_read_b64_tr_b16 v[82:83], v244 offset:1792
    ds_read_b64_tr_b16 v[84:85], v245 offset:0
    ds_read_b64_tr_b16 v[86:87], v245 offset:1792
    ds_read_b64_tr_b16 v[88:89], v246 offset:0
    ds_read_b64_tr_b16 v[90:91], v246 offset:1792
    ds_read_b64_tr_b16 v[92:93], v247 offset:0
    ds_read_b64_tr_b16 v[94:95], v247 offset:1792
    ds_read_b64_tr_b16 v[96:97], v248 offset:0
    ds_read_b64_tr_b16 v[98:99], v248 offset:1792
    ds_read_b64_tr_b16 v[100:101], v249 offset:0
    ds_read_b64_tr_b16 v[102:103], v249 offset:1792
    ds_read_b64_tr_b16 v[104:105], v250 offset:0
    ds_read_b64_tr_b16 v[106:107], v250 offset:1792
    s_mov_b32 s70, 9
Lc_12:
    s_waitcnt lgkmcnt(0)
    v_mfma_f32_16x16x32_bf16 v[16:19], v[80:83], v[72:75], v[16:19]
    ds_read_b128 v[108:111], v8 offset:1024
    ds_read_b128 v[112:115], v8 offset:3072
    v_mfma_f32_16x16x32_bf16 v[44:47], v[80:83], v[76:79], v[44:47]
    ds_read_b64_tr_b16 v[116:117], v244 offset:7168
    ds_read_b64_tr_b16 v[118:119], v244 offset:8960
    v_mfma_f32_16x16x32_bf16 v[20:23], v[84:87], v[72:75], v[20:23]
    ds_read_b64_tr_b16 v[120:121], v245 offset:7168
    ds_read_b64_tr_b16 v[122:123], v245 offset:8960
    v_mfma_f32_16x16x32_bf16 v[48:51], v[84:87], v[76:79], v[48:51]
    ds_read_b64_tr_b16 v[124:125], v246 offset:7168
    ds_read_b64_tr_b16 v[126:127], v246 offset:8960
    v_mfma_f32_16x16x32_bf16 v[24:27], v[88:91], v[72:75], v[24:27]
    ds_read_b64_tr_b16 v[128:129], v247 offset:7168
    ds_read_b64_tr_b16 v[130:131], v247 offset:8960
    v_mfma_f32_16x16x32_bf16 v[52:55], v[88:91], v[76:79], v[52:55]
    ds_read_b64_tr_b16 v[132:133], v248 offset:7168
    ds_read_b64_tr_b16 v[134:135], v248 offset:8960
    v_mfma_f32_16x16x32_bf16 v[28:31], v[92:95], v[72:75], v[28:31]
    ds_read_b64_tr_b16 v[136:137], v249 offset:7168
    ds_read_b64_tr_b16 v[138:139], v249 offset:8960
    v_mfma_f32_16x16x32_bf16 v[56:59], v[92:95], v[76:79], v[56:59]
    ds_read_b64_tr_b16 v[140:141], v250 offset:7168
    ds_read_b64_tr_b16 v[142:143], v250 offset:8960
    v_mfma_f32_16x16x32_bf16 v[32:35], v[96:99], v[72:75], v[32:35]
    v_mfma_f32_16x16x32_bf16 v[60:63], v[96:99], v[76:79], v[60:63]
    v_mfma_f32_16x16x32_bf16 v[36:39], v[100:103], v[72:75], v[36:39]
    v_mfma_f32_16x16x32_bf16 v[64:67], v[100:103], v[76:79], v[64:67]
    v_mfma_f32_16x16x32_bf16 v[40:43], v[104:107], v[72:75], v[40:43]
    v_mfma_f32_16x16x32_bf16 v[68:71], v[104:107], v[76:79], v[68:71]
    v_mfma_f32_16x16x32_bf16 v[144:147], v[80:83], v[152:155], v[144:147]
    v_mfma_f32_16x16x32_bf16 v[148:151], v[84:87], v[152:155], v[148:151]
    s_add_u32 s69, s69, 32768
    s_cmp_ge_u32 s69, 163840
    s_cselect_b32 s73, 163840, 0
    s_sub_u32 s69, s69, s73
    s_sub_u32 s73, 32768, s73
    v_add_u32 v8, s73, v8
    v_add_u32 v244, s73, v244
    v_add_u32 v245, s73, v245
    v_add_u32 v246, s73, v246
    v_add_u32 v247, s73, v247
    v_add_u32 v248, s73, v248
    v_add_u32 v249, s73, v249
    v_add_u32 v250, s73, v250
    s_waitcnt lgkmcnt(0)
    v_mfma_f32_16x16x32_bf16 v[16:19], v[116:119], v[108:111], v[16:19]
    ds_read_b128 v[72:75], v8 offset:0
    ds_read_b128 v[76:79], v8 offset:2048
    v_mfma_f32_16x16x32_bf16 v[44:47], v[116:119], v[112:115], v[44:47]
    ds_read_b64_tr_b16 v[80:81], v244 offset:0
    ds_read_b64_tr_b16 v[82:83], v244 offset:1792
    v_mfma_f32_16x16x32_bf16 v[20:23], v[120:123], v[108:111], v[20:23]
    ds_read_b64_tr_b16 v[84:85], v245 offset:0
    ds_read_b64_tr_b16 v[86:87], v245 offset:1792
    v_mfma_f32_16x16x32_bf16 v[48:51], v[120:123], v[112:115], v[48:51]
    ds_read_b64_tr_b16 v[88:89], v246 offset:0
    ds_read_b64_tr_b16 v[90:91], v246 offset:1792
    v_mfma_f32_16x16x32_bf16 v[24:27], v[124:127], v[108:111], v[24:27]
    ds_read_b64_tr_b16 v[92:93], v247 offset:0
    ds_read_b64_tr_b16 v[94:95], v247 offset:1792
    v_mfma_f32_16x16x32_bf16 v[52:55], v[124:127], v[112:115], v[52:55]
    ds_read_b64_tr_b16 v[96:97], v248 offset:0
    ds_read_b64_tr_b16 v[98:99], v248 offset:1792
    v_mfma_f32_16x16x32_bf16 v[28:31], v[128:131], v[108:111], v[28:31]
    ds_read_b64_tr_b16 v[100:101], v249 offset:0
    ds_read_b64_tr_b16 v[102:103], v249 offset:1792
    v_mfma_f32_16x16x32_bf16 v[56:59], v[128:131], v[112:115], v[56:59]
    ds_read_b64_tr_b16 v[104:105], v250 offset:0
    ds_read_b64_tr_b16 v[106:107], v250 offset:1792
    v_mfma_f32_16x16x32_bf16 v[32:35], v[132:135], v[108:111], v[32:35]
    v_mfma_f32_16x16x32_bf16 v[60:63], v[132:135], v[112:115], v[60:63]
    v_mfma_f32_16x16x32_bf16 v[36:39], v[136:139], v[108:111], v[36:39]
    v_mfma_f32_16x16x32_bf16 v[64:67], v[136:139], v[112:115], v[64:67]
    v_mfma_f32_16x16x32_bf16 v[40:43], v[140:143], v[108:111], v[40:43]
    v_mfma_f32_16x16x32_bf16 v[68:71], v[140:143], v[112:115], v[68:71]
    v_mfma_f32_16x16x32_bf16 v[144:147], v[116:119], v[152:155], v[144:147]
    v_mfma_f32_16x16x32_bf16 v[148:151], v[120:123], v[152:155], v[148:151]
    s_cmp_lg_u32 s70, 7
    s_cbranch_scc1 Ldr_13
    s_waitcnt vmcnt(0)
Ldr_13:
    s_cmp_lg_u32 s70, 6
    s_cbranch_scc1 Lmid_14
    s_lshl_b32 s73, s66, 5
    s_add_u32 s73, s73, s64
    v_add_u32 v4, s73, v2
    v_lshlrev_b32 v4, 3, v4
    v_lshl_add_u32 v4, v3, 15, v4
    s_mov_b32 s73, 16384
    buffer_load_dwordx2 v[176:177], v4, s[60:63], 0 offen offset:0 sc1
    buffer_load_dwordx2 v[178:179], v4, s[60:63], s73 offen offset:0 sc1
    buffer_load_dwordx2 v[180:181], v4, s[60:63], 0 offen offset:128 sc1
    buffer_load_dwordx2 v[182:183], v4, s[60:63], s73 offen offset:128 sc1
Lmid_14:
    s_barrier
    s_sub_u32 s70, s70, 1
    s_cmp_lg_u32 s70, 0
    s_cbranch_scc1 Lc_12
    s_waitcnt lgkmcnt(0)
    v_mfma_f32_16x16x32_bf16 v[16:19], v[80:83], v[72:75], v[16:19]
    ds_read_b128 v[108:111], v8 offset:1024
    ds_read_b128 v[112:115], v8 offset:3072
    v_mfma_f32_16x16x32_bf16 v[44:47], v[80:83], v[76:79], v[44:47]
    ds_read_b64_tr_b16 v[116:117], v244 offset:7168
    ds_read_b64_tr_b16 v[118:119], v244 offset:8960
    v_mfma_f32_16x16x32_bf16 v[20:23], v[84:87], v[72:75], v[20:23]
    ds_read_b64_tr_b16 v[120:121], v245 offset:7168
    ds_read_b64_tr_b16 v[122:123], v245 offset:8960
    v_mfma_f32_16x16x32_bf16 v[48:51], v[84:87], v[76:79], v[48:51]
    ds_read_b64_tr_b16 v[124:125], v246 offset:7168
    ds_read_b64_tr_b16 v[126:127], v246 offset:8960
    v_mfma_f32_16x16x32_bf16 v[24:27], v[88:91], v[72:75], v[24:27]
    ds_read_b64_tr_b16 v[128:129], v247 offset:7168
    ds_read_b64_tr_b16 v[130:131], v247 offset:8960
    v_mfma_f32_16x16x32_bf16 v[52:55], v[88:91], v[76:79], v[52:55]
    ds_read_b64_tr_b16 v[132:133], v248 offset:7168
    ds_read_b64_tr_b16 v[134:135], v248 offset:8960
    v_mfma_f32_16x16x32_bf16 v[28:31], v[92:95], v[72:75], v[28:31]
    ds_read_b64_tr_b16 v[136:137], v249 offset:7168
    ds_read_b64_tr_b16 v[138:139], v249 offset:8960
    v_mfma_f32_16x16x32_bf16 v[56:59], v[92:95], v[76:79], v[56:59]
    ds_read_b64_tr_b16 v[140:141], v250 offset:7168
    ds_read_b64_tr_b16 v[142:143], v250 offset:8960
    v_mfma_f32_16x16x32_bf16 v[32:35], v[96:99], v[72:75], v[32:35]
    v_mfma_f32_16x16x32_bf16 v[60:63], v[96:99], v[76:79], v[60:63]
    v_mfma_f32_16x16x32_bf16 v[36:39], v[100:103], v[72:75], v[36:39]
    v_mfma_f32_16x16x32_bf16 v[64:67], v[100:103], v[76:79], v[64:67]
    v_mfma_f32_16x16x32_bf16 v[40:43], v[104:107], v[72:75], v[40:43]
    v_mfma_f32_16x16x32_bf16 v[68:71], v[104:107], v[76:79], v[68:71]
    v_mfma_f32_16x16x32_bf16 v[144:147], v[80:83], v[152:155], v[144:147]
    v_mfma_f32_16x16x32_bf16 v[148:151], v[84:87], v[152:155], v[148:151]
    s_waitcnt lgkmcnt(0)
    v_mfma_f32_16x16x32_bf16 v[16:19], v[116:119], v[108:111], v[16:19]
    v_mfma_f32_16x16x32_bf16 v[44:47], v[116:119], v[112:115], v[44:47]
    v_mfma_f32_16x16x32_bf16 v[20:23], v[120:123], v[108:111], v[20:23]
    v_mfma_f32_16x16x32_bf16 v[48:51], v[120:123], v[112:115], v[48:51]
    v_mfma_f32_16x16x32_bf16 v[24:27], v[124:127], v[108:111], v[24:27]
    v_mfma_f32_16x16x32_bf16 v[52:55], v[124:127], v[112:115], v[52:55]
    v_mfma_f32_16x16x32_bf16 v[28:31], v[128:131], v[108:111], v[28:31]
    v_mfma_f32_16x16x32_bf16 v[56:59], v[128:131], v[112:115], v[56:59]
    v_mfma_f32_16x16x32_bf16 v[32:35], v[132:135], v[108:111], v[32:35]
    v_mfma_f32_16x16x32_bf16 v[60:63], v[132:135], v[112:115], v[60:63]
    v_mfma_f32_16x16x32_bf16 v[36:39], v[136:139], v[108:111], v[36:39]
    v_mfma_f32_16x16x32_bf16 v[64:67], v[136:139], v[112:115], v[64:67]
    v_mfma_f32_16x16x32_bf16 v[40:43], v[140:143], v[108:111], v[40:43]
    v_mfma_f32_16x16x32_bf16 v[68:71], v[140:143], v[112:115], v[68:71]
    v_mfma_f32_16x16x32_bf16 v[144:147], v[116:119], v[152:155], v[144:147]
    v_mfma_f32_16x16x32_bf16 v[148:151], v[120:123], v[152:155], v[148:151]
    s_nop 9
    v_cmp_eq_u32 s[80:81], 0, v2
    s_mul_i32 s73, s66, 2
    s_add_u32 s73, s73, 0
    s_cmp_ge_u32 s73, 7
    s_cselect_b32 s91, 7, 0
    s_sub_u32 s73, s73, s91
    s_lshl_b32 s73, s73, 6
    s_add_u32 s73, s73, 98304
    v_lshl_add_u32 v4, v3, 4, s73
    s_mul_i32 s73, s66, 2
    s_add_u32 s73, s73, 1
    s_cmp_ge_u32 s73, 7
    s_cselect_b32 s91, 7, 0
    s_sub_u32 s73, s73, s91
    s_lshl_b32 s73, s73, 6
    s_add_u32 s73, s73, 98304
    v_lshl_add_u32 v5, v3, 4, s73
    s_mov_b64 exec, s[80:81]
    ds_write_b128 v4, v[144:147]
    ds_write_b128 v5, v[148:151]
    s_mov_b64 exec, -1
    s_waitcnt lgkmcnt(0)
    s_barrier
    s_mul_i32 s73, s66, 2
    s_add_u32 s73, s73, 0
    s_cmp_ge_u32 s73, 7
    s_cselect_b32 s91, 7, 0
    s_sub_u32 s73, s73, s91
    s_lshl_b32 s73, s73, 6
    s_add_u32 s73, s73, 98304
    v_lshl_add_u32 v4, v3, 4, s73
    ds_read_b128 v[108:111], v4
    s_mul_i32 s73, s66, 2
    s_add_u32 s73, s73, 1
    s_cmp_ge_u32 s73, 7
    s_cselect_b32 s91, 7, 0
    s_sub_u32 s73, s73, s91
    s_lshl_b32 s73, s73, 6
    s_add_u32 s73, s73, 98304
    v_lshl_add_u32 v4, v3, 4, s73
    ds_read_b128 v[112:115], v4
    s_mul_i32 s73, s66, 2
    s_add_u32 s73, s73, 2
    s_cmp_ge_u32 s73, 7
    s_cselect_b32 s91, 7, 0
    s_sub_u32 s73, s73, s91
    s_lshl_b32 s73, s73, 6
    s_add_u32 s73, s73, 98304
    v_lshl_add_u32 v4, v3, 4, s73
    ds_read_b128 v[116:119], v4
    s_mul_i32 s73, s66, 2
    s_add_u32 s73, s73, 3
    s_cmp_ge_u32 s73, 7
    s_cselect_b32 s91, 7, 0
    s_sub_u32 s73, s73, s91
    s_lshl_b32 s73, s73, 6
    s_add_u32 s73, s73, 98304
    v_lshl_add_u32 v4, v3, 4, s73
    ds_read_b128 v[120:123], v4
    s_mul_i32 s73, s66, 2
    s_add_u32 s73, s73, 4
    s_cmp_ge_u32 s73, 7
    s_cselect_b32 s91, 7, 0
    s_sub_u32 s73, s73, s91
    s_lshl_b32 s73, s73, 6
    s_add_u32 s73, s73, 98304
    v_lshl_add_u32 v4, v3, 4, s73
    ds_read_b128 v[124:127], v4
    s_mul_i32 s73, s66, 2
    s_add_u32 s73, s73, 5
    s_cmp_ge_u32 s73, 7
    s_cselect_b32 s91, 7, 0
    s_sub_u32 s73, s73, s91
    s_lshl_b32 s73, s73, 6
    s_add_u32 s73, s73, 98304
    v_lshl_add_u32 v4, v3, 4, s73
    ds_read_b128 v[128:131], v4
    s_mul_i32 s73, s66, 2
    s_add_u32 s73, s73, 6
    s_cmp_ge_u32 s73, 7
    s_cselect_b32 s91, 7, 0
    s_sub_u32 s73, s73, s91
    s_lshl_b32 s73, s73, 6
    s_add_u32 s73, s73, 98304
    v_lshl_add_u32 v4, v3, 4, s73
    ds_read_b128 v[132:135], v4
    v_mov_b32 v236, 0xbdd2d3e8
    v_mov_b32 v238, 0xc0135761
    v_mov_b32 v240, 1.0
    v_mov_b32 v237, 0xbdd2d3e8
    v_mov_b32 v239, 0xc0135761
    v_mov_b32 v241, 1.0
    s_waitcnt vmcnt(0)
    v_add_f32 v176, v176, v178
    v_add_f32 v177, v177, v179
    v_add_f32 v180, v180, v182
    v_add_f32 v181, v181, v183
    v_mov_b32 v72, v176
    v_mov_b32 v73, v176
    s_nop 1
    v_permlane32_swap_b32 v72, v73
    s_nop 0
    v_add_f32 v176, v72, v73
    v_mov_b32 v72, v177
    v_mov_b32 v73, v177
    s_nop 1
    v_permlane32_swap_b32 v72, v73
    s_nop 0
    v_add_f32 v177, v72, v73
    v_mov_b32 v72, v180
    v_mov_b32 v73, v180
    s_nop 1
    v_permlane32_swap_b32 v72, v73
    s_nop 0
    v_add_f32 v180, v72, v73
    v_mov_b32 v72, v181
    v_mov_b32 v73, v181
    s_nop 1
    v_permlane32_swap_b32 v72, v73
    s_nop 0
    v_add_f32 v181, v72, v73
    v_mov_b32 v72, v176
    v_mov_b32 v73, v176
    s_nop 1
    v_permlane16_swap_b32 v72, v73
    s_nop 0
    v_add_f32 v176, v72, v73
    v_mov_b32 v72, v177
    v_mov_b32 v73, v177
    s_nop 1
    v_permlane16_swap_b32 v72, v73
    s_nop 0
    v_add_f32 v177, v72, v73
    v_mov_b32 v72, v180
    v_mov_b32 v73, v180
    s_nop 1
    v_permlane16_swap_b32 v72, v73
    s_nop 0
    v_add_f32 v180, v72, v73
    v_mov_b32 v72, v181
    v_mov_b32 v73, v181
    s_nop 1
    v_permlane16_swap_b32 v72, v73
    s_nop 0
    v_add_f32 v181, v72, v73
    v_mul_f32 v176, 0x3acccccd, v176
    v_mul_f32 v177, 0x3acccccd, v177
    v_fma_f32 v177, -v176, v176, v177
    v_max_f32 v177, 0, v177
    v_cvt_pk_bf16_f32 v184, v176, v176
    v_lshlrev_b32 v184, 16, v184
    v_cvt_pk_bf16_f32 v4, v177, v177
    v_lshlrev_b32 v4, 16, v4
    v_add_f32 v4, 0x3727c5ac, v4
    v_cvt_pk_bf16_f32 v4, v4, v4
    v_lshlrev_b32 v4, 16, v4
    v_sqrt_f32 v4, v4
    s_nop 0
    v_cvt_pk_bf16_f32 v4, v4, v4
    v_lshlrev_b32 v4, 16, v4
    v_rcp_f32 v178, v4
    s_nop 0
    v_mov_b32 v179, v178
    v_mul_f32 v180, 0x3acccccd, v180
    v_mul_f32 v181, 0x3acccccd, v181
    v_fma_f32 v181, -v180, v180, v181
    v_max_f32 v181, 0, v181
    v_cvt_pk_bf16_f32 v185, v180, v180
    v_lshlrev_b32 v185, 16, v185
    v_cvt_pk_bf16_f32 v4, v181, v181
    v_lshlrev_b32 v4, 16, v4
    v_add_f32 v4, 0x3727c5ac, v4
    v_cvt_pk_bf16_f32 v4, v4, v4
    v_lshlrev_b32 v4, 16, v4
    v_sqrt_f32 v4, v4
    s_nop 0
    v_cvt_pk_bf16_f32 v4, v4, v4
    v_lshlrev_b32 v4, 16, v4
    v_rcp_f32 v182, v4
    s_nop 0
    v_mov_b32 v183, v182
    s_waitcnt lgkmcnt(0)
    s_mul_i32 s71, s66, 2
    s_add_u32 s71, s71, 0
    s_cmp_ge_u32 s71, 7
    s_cselect_b32 s91, 7, 0
    s_sub_u32 s71, s71, s91
    s_lshl_b32 s71, s71, 9
    s_mul_i32 s72, s66, 2
    s_add_u32 s72, s72, 1
    s_cmp_ge_u32 s72, 7
    s_cselect_b32 s91, 7, 0
    s_sub_u32 s72, s72, s91
    s_lshl_b32 s72, s72, 9
    s_sub_u32 s72, s72, s71
    v_mad_i32_i24 v234, v243, s72, v242
    v_add_u32 v234, s71, v234
    s_mov_b32 s71, 0
    s_add_u32 s72, s71, 55296
    v_fma_f32 v16, -v184, v108, v16
    v_fma_f32 v17, -v184, v109, v17
    v_fma_f32 v18, -v184, v110, v18
    v_fma_f32 v19, -v184, v111, v19
    v_pk_mul_f32 v[16:17], v[16:17], v[178:179]
    v_pk_mul_f32 v[18:19], v[18:19], v[178:179]
    v_cvt_pk_bf16_f32 v76, v16, v17
    v_cvt_pk_bf16_f32 v77, v18, v19
    v_lshlrev_b32 v16, 16, v76
    v_and_b32 v17, 0xffff0000, v76
    v_lshlrev_b32 v18, 16, v77
    v_and_b32 v19, 0xffff0000, v77
    v_pk_mul_f32 v[72:73], v[16:17], v[16:17]
    v_pk_mul_f32 v[74:75], v[18:19], v[18:19]
    v_pk_fma_f32 v[72:73], v[72:73], v[236:237], v[238:239]
    v_pk_fma_f32 v[74:75], v[74:75], v[236:237], v[238:239]
    v_pk_mul_f32 v[72:73], v[72:73], v[16:17]
    v_pk_mul_f32 v[74:75], v[74:75], v[18:19]
    v_exp_f32 v72, v72
    v_exp_f32 v73, v73
    v_exp_f32 v74, v74
    v_exp_f32 v75, v75
    s_nop 0
    v_pk_add_f32 v[72:73], v[72:73], v[240:241]
    v_pk_add_f32 v[74:75], v[74:75], v[240:241]
    v_rcp_f32 v72, v72
    v_rcp_f32 v73, v73
    v_rcp_f32 v74, v74
    v_rcp_f32 v75, v75
    s_nop 0
    v_pk_mul_f32 v[16:17], v[16:17], v[72:73]
    v_pk_mul_f32 v[18:19], v[18:19], v[74:75]
    v_cvt_pk_bf16_f32 v80, v16, v17
    v_cvt_pk_bf16_f32 v81, v18, v19
    v_fma_f32 v20, -v184, v112, v20
    v_fma_f32 v21, -v184, v113, v21
    v_fma_f32 v22, -v184, v114, v22
    v_fma_f32 v23, -v184, v115, v23
    v_pk_mul_f32 v[20:21], v[20:21], v[178:179]
    v_pk_mul_f32 v[22:23], v[22:23], v[178:179]
    v_cvt_pk_bf16_f32 v76, v20, v21
    v_cvt_pk_bf16_f32 v77, v22, v23
    v_lshlrev_b32 v20, 16, v76
    v_and_b32 v21, 0xffff0000, v76
    v_lshlrev_b32 v22, 16, v77
    v_and_b32 v23, 0xffff0000, v77
    v_pk_mul_f32 v[72:73], v[20:21], v[20:21]
    v_pk_mul_f32 v[74:75], v[22:23], v[22:23]
    v_pk_fma_f32 v[72:73], v[72:73], v[236:237], v[238:239]
    v_pk_fma_f32 v[74:75], v[74:75], v[236:237], v[238:239]
    v_pk_mul_f32 v[72:73], v[72:73], v[20:21]
    v_pk_mul_f32 v[74:75], v[74:75], v[22:23]
    v_exp_f32 v72, v72
    v_exp_f32 v73, v73
    v_exp_f32 v74, v74
    v_exp_f32 v75, v75
    s_nop 0
    v_pk_add_f32 v[72:73], v[72:73], v[240:241]
    v_pk_add_f32 v[74:75], v[74:75], v[240:241]
    v_rcp_f32 v72, v72
    v_rcp_f32 v73, v73
    v_rcp_f32 v74, v74
    v_rcp_f32 v75, v75
    s_nop 0
    v_pk_mul_f32 v[20:21], v[20:21], v[72:73]
    v_pk_mul_f32 v[22:23], v[22:23], v[74:75]
    v_cvt_pk_bf16_f32 v82, v20, v21
    v_cvt_pk_bf16_f32 v83, v22, v23
    s_nop 1
    v_permlane16_swap_b32 v80, v82
    v_permlane16_swap_b32 v81, v83
    buffer_store_dwordx4 v[80:83], v234, s[48:51], s71 offen offset:0 sc1
    v_fma_f32 v44, -v185, v108, v44
    v_fma_f32 v45, -v185, v109, v45
    v_fma_f32 v46, -v185, v110, v46
    v_fma_f32 v47, -v185, v111, v47
    v_pk_mul_f32 v[44:45], v[44:45], v[182:183]
    v_pk_mul_f32 v[46:47], v[46:47], v[182:183]
    v_cvt_pk_bf16_f32 v76, v44, v45
    v_cvt_pk_bf16_f32 v77, v46, v47
    v_lshlrev_b32 v44, 16, v76
    v_and_b32 v45, 0xffff0000, v76
    v_lshlrev_b32 v46, 16, v77
    v_and_b32 v47, 0xffff0000, v77
    v_pk_mul_f32 v[72:73], v[44:45], v[44:45]
    v_pk_mul_f32 v[74:75], v[46:47], v[46:47]
    v_pk_fma_f32 v[72:73], v[72:73], v[236:237], v[238:239]
    v_pk_fma_f32 v[74:75], v[74:75], v[236:237], v[238:239]
    v_pk_mul_f32 v[72:73], v[72:73], v[44:45]
    v_pk_mul_f32 v[74:75], v[74:75], v[46:47]
    v_exp_f32 v72, v72
    v_exp_f32 v73, v73
    v_exp_f32 v74, v74
    v_exp_f32 v75, v75
    s_nop 0
    v_pk_add_f32 v[72:73], v[72:73], v[240:241]
    v_pk_add_f32 v[74:75], v[74:75], v[240:241]
    v_rcp_f32 v72, v72
    v_rcp_f32 v73, v73
    v_rcp_f32 v74, v74
    v_rcp_f32 v75, v75
    s_nop 0
    v_pk_mul_f32 v[44:45], v[44:45], v[72:73]
    v_pk_mul_f32 v[46:47], v[46:47], v[74:75]
    v_cvt_pk_bf16_f32 v84, v44, v45
    v_cvt_pk_bf16_f32 v85, v46, v47
    v_fma_f32 v48, -v185, v112, v48
    v_fma_f32 v49, -v185, v113, v49
    v_fma_f32 v50, -v185, v114, v50
    v_fma_f32 v51, -v185, v115, v51
    v_pk_mul_f32 v[48:49], v[48:49], v[182:183]
    v_pk_mul_f32 v[50:51], v[50:51], v[182:183]
    v_cvt_pk_bf16_f32 v76, v48, v49
    v_cvt_pk_bf16_f32 v77, v50, v51
    v_lshlrev_b32 v48, 16, v76
    v_and_b32 v49, 0xffff0000, v76
    v_lshlrev_b32 v50, 16, v77
    v_and_b32 v51, 0xffff0000, v77
    v_pk_mul_f32 v[72:73], v[48:49], v[48:49]
    v_pk_mul_f32 v[74:75], v[50:51], v[50:51]
    v_pk_fma_f32 v[72:73], v[72:73], v[236:237], v[238:239]
    v_pk_fma_f32 v[74:75], v[74:75], v[236:237], v[238:239]
    v_pk_mul_f32 v[72:73], v[72:73], v[48:49]
    v_pk_mul_f32 v[74:75], v[74:75], v[50:51]
    v_exp_f32 v72, v72
    v_exp_f32 v73, v73
    v_exp_f32 v74, v74
    v_exp_f32 v75, v75
    s_nop 0
    v_pk_add_f32 v[72:73], v[72:73], v[240:241]
    v_pk_add_f32 v[74:75], v[74:75], v[240:241]
    v_rcp_f32 v72, v72
    v_rcp_f32 v73, v73
    v_rcp_f32 v74, v74
    v_rcp_f32 v75, v75
    s_nop 0
    v_pk_mul_f32 v[48:49], v[48:49], v[72:73]
    v_pk_mul_f32 v[50:51], v[50:51], v[74:75]
    v_cvt_pk_bf16_f32 v86, v48, v49
    v_cvt_pk_bf16_f32 v87, v50, v51
    s_nop 1
    v_permlane16_swap_b32 v84, v86
    v_permlane16_swap_b32 v85, v87
    buffer_store_dwordx4 v[84:87], v234, s[48:51], s72 offen offset:0 sc1
    s_mul_i32 s71, s66, 2
    s_add_u32 s71, s71, 2
    s_cmp_ge_u32 s71, 7
    s_cselect_b32 s91, 7, 0
    s_sub_u32 s71, s71, s91
    s_lshl_b32 s71, s71, 9
    s_mul_i32 s72, s66, 2
    s_add_u32 s72, s72, 3
    s_cmp_ge_u32 s72, 7
    s_cselect_b32 s91, 7, 0
    s_sub_u32 s72, s72, s91
    s_lshl_b32 s72, s72, 9
    s_sub_u32 s72, s72, s71
    v_mad_i32_i24 v234, v243, s72, v242
    v_add_u32 v234, s71, v234
    s_mov_b32 s71, 0
    s_add_u32 s72, s71, 55296
    v_fma_f32 v24, -v184, v116, v24
    v_fma_f32 v25, -v184, v117, v25
    v_fma_f32 v26, -v184, v118, v26
    v_fma_f32 v27, -v184, v119, v27
    v_pk_mul_f32 v[24:25], v[24:25], v[178:179]
    v_pk_mul_f32 v[26:27], v[26:27], v[178:179]
    v_cvt_pk_bf16_f32 v76, v24, v25
    v_cvt_pk_bf16_f32 v77, v26, v27
    v_lshlrev_b32 v24, 16, v76
    v_and_b32 v25, 0xffff0000, v76
    v_lshlrev_b32 v26, 16, v77
    v_and_b32 v27, 0xffff0000, v77
    v_pk_mul_f32 v[72:73], v[24:25], v[24:25]
    v_pk_mul_f32 v[74:75], v[26:27], v[26:27]
    v_pk_fma_f32 v[72:73], v[72:73], v[236:237], v[238:239]
    v_pk_fma_f32 v[74:75], v[74:75], v[236:237], v[238:239]
    v_pk_mul_f32 v[72:73], v[72:73], v[24:25]
    v_pk_mul_f32 v[74:75], v[74:75], v[26:27]
    v_exp_f32 v72, v72
    v_exp_f32 v73, v73
    v_exp_f32 v74, v74
    v_exp_f32 v75, v75
    s_nop 0
    v_pk_add_f32 v[72:73], v[72:73], v[240:241]
    v_pk_add_f32 v[74:75], v[74:75], v[240:241]
    v_rcp_f32 v72, v72
    v_rcp_f32 v73, v73
    v_rcp_f32 v74, v74
    v_rcp_f32 v75, v75
    s_nop 0
    v_pk_mul_f32 v[24:25], v[24:25], v[72:73]
    v_pk_mul_f32 v[26:27], v[26:27], v[74:75]
    v_cvt_pk_bf16_f32 v88, v24, v25
    v_cvt_pk_bf16_f32 v89, v26, v27
    v_fma_f32 v28, -v184, v120, v28
    v_fma_f32 v29, -v184, v121, v29
    v_fma_f32 v30, -v184, v122, v30
    v_fma_f32 v31, -v184, v123, v31
    v_pk_mul_f32 v[28:29], v[28:29], v[178:179]
    v_pk_mul_f32 v[30:31], v[30:31], v[178:179]
    v_cvt_pk_bf16_f32 v76, v28, v29
    v_cvt_pk_bf16_f32 v77, v30, v31
    v_lshlrev_b32 v28, 16, v76
    v_and_b32 v29, 0xffff0000, v76
    v_lshlrev_b32 v30, 16, v77
    v_and_b32 v31, 0xffff0000, v77
    v_pk_mul_f32 v[72:73], v[28:29], v[28:29]
    v_pk_mul_f32 v[74:75], v[30:31], v[30:31]
    v_pk_fma_f32 v[72:73], v[72:73], v[236:237], v[238:239]
    v_pk_fma_f32 v[74:75], v[74:75], v[236:237], v[238:239]
    v_pk_mul_f32 v[72:73], v[72:73], v[28:29]
    v_pk_mul_f32 v[74:75], v[74:75], v[30:31]
    v_exp_f32 v72, v72
    v_exp_f32 v73, v73
    v_exp_f32 v74, v74
    v_exp_f32 v75, v75
    s_nop 0
    v_pk_add_f32 v[72:73], v[72:73], v[240:241]
    v_pk_add_f32 v[74:75], v[74:75], v[240:241]
    v_rcp_f32 v72, v72
    v_rcp_f32 v73, v73
    v_rcp_f32 v74, v74
    v_rcp_f32 v75, v75
    s_nop 0
    v_pk_mul_f32 v[28:29], v[28:29], v[72:73]
    v_pk_mul_f32 v[30:31], v[30:31], v[74:75]
    v_cvt_pk_bf16_f32 v90, v28, v29
    v_cvt_pk_bf16_f32 v91, v30, v31
    s_nop 1
    v_permlane16_swap_b32 v88, v90
    v_permlane16_swap_b32 v89, v91
    buffer_store_dwordx4 v[88:91], v234, s[48:51], s71 offen offset:0 sc1
    v_fma_f32 v52, -v185, v116, v52
    v_fma_f32 v53, -v185, v117, v53
    v_fma_f32 v54, -v185, v118, v54
    v_fma_f32 v55, -v185, v119, v55
    v_pk_mul_f32 v[52:53], v[52:53], v[182:183]
    v_pk_mul_f32 v[54:55], v[54:55], v[182:183]
    v_cvt_pk_bf16_f32 v76, v52, v53
    v_cvt_pk_bf16_f32 v77, v54, v55
    v_lshlrev_b32 v52, 16, v76
    v_and_b32 v53, 0xffff0000, v76
    v_lshlrev_b32 v54, 16, v77
    v_and_b32 v55, 0xffff0000, v77
    v_pk_mul_f32 v[72:73], v[52:53], v[52:53]
    v_pk_mul_f32 v[74:75], v[54:55], v[54:55]
    v_pk_fma_f32 v[72:73], v[72:73], v[236:237], v[238:239]
    v_pk_fma_f32 v[74:75], v[74:75], v[236:237], v[238:239]
    v_pk_mul_f32 v[72:73], v[72:73], v[52:53]
    v_pk_mul_f32 v[74:75], v[74:75], v[54:55]
    v_exp_f32 v72, v72
    v_exp_f32 v73, v73
    v_exp_f32 v74, v74
    v_exp_f32 v75, v75
    s_nop 0
    v_pk_add_f32 v[72:73], v[72:73], v[240:241]
    v_pk_add_f32 v[74:75], v[74:75], v[240:241]
    v_rcp_f32 v72, v72
    v_rcp_f32 v73, v73
    v_rcp_f32 v74, v74
    v_rcp_f32 v75, v75
    s_nop 0
    v_pk_mul_f32 v[52:53], v[52:53], v[72:73]
    v_pk_mul_f32 v[54:55], v[54:55], v[74:75]
    v_cvt_pk_bf16_f32 v92, v52, v53
    v_cvt_pk_bf16_f32 v93, v54, v55
    v_fma_f32 v56, -v185, v120, v56
    v_fma_f32 v57, -v185, v121, v57
    v_fma_f32 v58, -v185, v122, v58
    v_fma_f32 v59, -v185, v123, v59
    v_pk_mul_f32 v[56:57], v[56:57], v[182:183]
    v_pk_mul_f32 v[58:59], v[58:59], v[182:183]
    v_cvt_pk_bf16_f32 v76, v56, v57
    v_cvt_pk_bf16_f32 v77, v58, v59
    v_lshlrev_b32 v56, 16, v76
    v_and_b32 v57, 0xffff0000, v76
    v_lshlrev_b32 v58, 16, v77
    v_and_b32 v59, 0xffff0000, v77
    v_pk_mul_f32 v[72:73], v[56:57], v[56:57]
    v_pk_mul_f32 v[74:75], v[58:59], v[58:59]
    v_pk_fma_f32 v[72:73], v[72:73], v[236:237], v[238:239]
    v_pk_fma_f32 v[74:75], v[74:75], v[236:237], v[238:239]
    v_pk_mul_f32 v[72:73], v[72:73], v[56:57]
    v_pk_mul_f32 v[74:75], v[74:75], v[58:59]
    v_exp_f32 v72, v72
    v_exp_f32 v73, v73
    v_exp_f32 v74, v74
    v_exp_f32 v75, v75
    s_nop 0
    v_pk_add_f32 v[72:73], v[72:73], v[240:241]
    v_pk_add_f32 v[74:75], v[74:75], v[240:241]
    v_rcp_f32 v72, v72
    v_rcp_f32 v73, v73
    v_rcp_f32 v74, v74
    v_rcp_f32 v75, v75
    s_nop 0
    v_pk_mul_f32 v[56:57], v[56:57], v[72:73]
    v_pk_mul_f32 v[58:59], v[58:59], v[74:75]
    v_cvt_pk_bf16_f32 v94, v56, v57
    v_cvt_pk_bf16_f32 v95, v58, v59
    s_nop 1
    v_permlane16_swap_b32 v92, v94
    v_permlane16_swap_b32 v93, v95
    buffer_store_dwordx4 v[92:95], v234, s[48:51], s72 offen offset:0 sc1
    s_mul_i32 s71, s66, 2
    s_add_u32 s71, s71, 4
    s_cmp_ge_u32 s71, 7
    s_cselect_b32 s91, 7, 0
    s_sub_u32 s71, s71, s91
    s_lshl_b32 s71, s71, 9
    s_mul_i32 s72, s66, 2
    s_add_u32 s72, s72, 5
    s_cmp_ge_u32 s72, 7
    s_cselect_b32 s91, 7, 0
    s_sub_u32 s72, s72, s91
    s_lshl_b32 s72, s72, 9
    s_sub_u32 s72, s72, s71
    v_mad_i32_i24 v234, v243, s72, v242
    v_add_u32 v234, s71, v234
    s_mov_b32 s71, 0
    s_add_u32 s72, s71, 55296
    v_fma_f32 v32, -v184, v124, v32
    v_fma_f32 v33, -v184, v125, v33
    v_fma_f32 v34, -v184, v126, v34
    v_fma_f32 v35, -v184, v127, v35
    v_pk_mul_f32 v[32:33], v[32:33], v[178:179]
    v_pk_mul_f32 v[34:35], v[34:35], v[178:179]
    v_cvt_pk_bf16_f32 v76, v32, v33
    v_cvt_pk_bf16_f32 v77, v34, v35
    v_lshlrev_b32 v32, 16, v76
    v_and_b32 v33, 0xffff0000, v76
    v_lshlrev_b32 v34, 16, v77
    v_and_b32 v35, 0xffff0000, v77
    v_pk_mul_f32 v[72:73], v[32:33], v[32:33]
    v_pk_mul_f32 v[74:75], v[34:35], v[34:35]
    v_pk_fma_f32 v[72:73], v[72:73], v[236:237], v[238:239]
    v_pk_fma_f32 v[74:75], v[74:75], v[236:237], v[238:239]
    v_pk_mul_f32 v[72:73], v[72:73], v[32:33]
    v_pk_mul_f32 v[74:75], v[74:75], v[34:35]
    v_exp_f32 v72, v72
    v_exp_f32 v73, v73
    v_exp_f32 v74, v74
    v_exp_f32 v75, v75
    s_nop 0
    v_pk_add_f32 v[72:73], v[72:73], v[240:241]
    v_pk_add_f32 v[74:75], v[74:75], v[240:241]
    v_rcp_f32 v72, v72
    v_rcp_f32 v73, v73
    v_rcp_f32 v74, v74
    v_rcp_f32 v75, v75
    s_nop 0
    v_pk_mul_f32 v[32:33], v[32:33], v[72:73]
    v_pk_mul_f32 v[34:35], v[34:35], v[74:75]
    v_cvt_pk_bf16_f32 v80, v32, v33
    v_cvt_pk_bf16_f32 v81, v34, v35
    v_fma_f32 v36, -v184, v128, v36
    v_fma_f32 v37, -v184, v129, v37
    v_fma_f32 v38, -v184, v130, v38
    v_fma_f32 v39, -v184, v131, v39
    v_pk_mul_f32 v[36:37], v[36:37], v[178:179]
    v_pk_mul_f32 v[38:39], v[38:39], v[178:179]
    v_cvt_pk_bf16_f32 v76, v36, v37
    v_cvt_pk_bf16_f32 v77, v38, v39
    v_lshlrev_b32 v36, 16, v76
    v_and_b32 v37, 0xffff0000, v76
    v_lshlrev_b32 v38, 16, v77
    v_and_b32 v39, 0xffff0000, v77
    v_pk_mul_f32 v[72:73], v[36:37], v[36:37]
    v_pk_mul_f32 v[74:75], v[38:39], v[38:39]
    v_pk_fma_f32 v[72:73], v[72:73], v[236:237], v[238:239]
    v_pk_fma_f32 v[74:75], v[74:75], v[236:237], v[238:239]
    v_pk_mul_f32 v[72:73], v[72:73], v[36:37]
    v_pk_mul_f32 v[74:75], v[74:75], v[38:39]
    v_exp_f32 v72, v72
    v_exp_f32 v73, v73
    v_exp_f32 v74, v74
    v_exp_f32 v75, v75
    s_nop 0
    v_pk_add_f32 v[72:73], v[72:73], v[240:241]
    v_pk_add_f32 v[74:75], v[74:75], v[240:241]
    v_rcp_f32 v72, v72
    v_rcp_f32 v73, v73
    v_rcp_f32 v74, v74
    v_rcp_f32 v75, v75
    s_nop 0
    v_pk_mul_f32 v[36:37], v[36:37], v[72:73]
    v_pk_mul_f32 v[38:39], v[38:39], v[74:75]
    v_cvt_pk_bf16_f32 v82, v36, v37
    v_cvt_pk_bf16_f32 v83, v38, v39
    s_nop 1
    v_permlane16_swap_b32 v80, v82
    v_permlane16_swap_b32 v81, v83
    buffer_store_dwordx4 v[80:83], v234, s[48:51], s71 offen offset:0 sc1
    v_fma_f32 v60, -v185, v124, v60
    v_fma_f32 v61, -v185, v125, v61
    v_fma_f32 v62, -v185, v126, v62
    v_fma_f32 v63, -v185, v127, v63
    v_pk_mul_f32 v[60:61], v[60:61], v[182:183]
    v_pk_mul_f32 v[62:63], v[62:63], v[182:183]
    v_cvt_pk_bf16_f32 v76, v60, v61
    v_cvt_pk_bf16_f32 v77, v62, v63
    v_lshlrev_b32 v60, 16, v76
    v_and_b32 v61, 0xffff0000, v76
    v_lshlrev_b32 v62, 16, v77
    v_and_b32 v63, 0xffff0000, v77
    v_pk_mul_f32 v[72:73], v[60:61], v[60:61]
    v_pk_mul_f32 v[74:75], v[62:63], v[62:63]
    v_pk_fma_f32 v[72:73], v[72:73], v[236:237], v[238:239]
    v_pk_fma_f32 v[74:75], v[74:75], v[236:237], v[238:239]
    v_pk_mul_f32 v[72:73], v[72:73], v[60:61]
    v_pk_mul_f32 v[74:75], v[74:75], v[62:63]
    v_exp_f32 v72, v72
    v_exp_f32 v73, v73
    v_exp_f32 v74, v74
    v_exp_f32 v75, v75
    s_nop 0
    v_pk_add_f32 v[72:73], v[72:73], v[240:241]
    v_pk_add_f32 v[74:75], v[74:75], v[240:241]
    v_rcp_f32 v72, v72
    v_rcp_f32 v73, v73
    v_rcp_f32 v74, v74
    v_rcp_f32 v75, v75
    s_nop 0
    v_pk_mul_f32 v[60:61], v[60:61], v[72:73]
    v_pk_mul_f32 v[62:63], v[62:63], v[74:75]
    v_cvt_pk_bf16_f32 v84, v60, v61
    v_cvt_pk_bf16_f32 v85, v62, v63
    v_fma_f32 v64, -v185, v128, v64
    v_fma_f32 v65, -v185, v129, v65
    v_fma_f32 v66, -v185, v130, v66
    v_fma_f32 v67, -v185, v131, v67
    v_pk_mul_f32 v[64:65], v[64:65], v[182:183]
    v_pk_mul_f32 v[66:67], v[66:67], v[182:183]
    v_cvt_pk_bf16_f32 v76, v64, v65
    v_cvt_pk_bf16_f32 v77, v66, v67
    v_lshlrev_b32 v64, 16, v76
    v_and_b32 v65, 0xffff0000, v76
    v_lshlrev_b32 v66, 16, v77
    v_and_b32 v67, 0xffff0000, v77
    v_pk_mul_f32 v[72:73], v[64:65], v[64:65]
    v_pk_mul_f32 v[74:75], v[66:67], v[66:67]
    v_pk_fma_f32 v[72:73], v[72:73], v[236:237], v[238:239]
    v_pk_fma_f32 v[74:75], v[74:75], v[236:237], v[238:239]
    v_pk_mul_f32 v[72:73], v[72:73], v[64:65]
    v_pk_mul_f32 v[74:75], v[74:75], v[66:67]
    v_exp_f32 v72, v72
    v_exp_f32 v73, v73
    v_exp_f32 v74, v74
    v_exp_f32 v75, v75
    s_nop 0
    v_pk_add_f32 v[72:73], v[72:73], v[240:241]
    v_pk_add_f32 v[74:75], v[74:75], v[240:241]
    v_rcp_f32 v72, v72
    v_rcp_f32 v73, v73
    v_rcp_f32 v74, v74
    v_rcp_f32 v75, v75
    s_nop 0
    v_pk_mul_f32 v[64:65], v[64:65], v[72:73]
    v_pk_mul_f32 v[66:67], v[66:67], v[74:75]
    v_cvt_pk_bf16_f32 v86, v64, v65
    v_cvt_pk_bf16_f32 v87, v66, v67
    s_nop 1
    v_permlane16_swap_b32 v84, v86
    v_permlane16_swap_b32 v85, v87
    buffer_store_dwordx4 v[84:87], v234, s[48:51], s72 offen offset:0 sc1
    s_mul_i32 s71, s66, 2
    s_add_u32 s71, s71, 6
    s_cmp_ge_u32 s71, 7
    s_cselect_b32 s91, 7, 0
    s_sub_u32 s71, s71, s91
    s_lshl_b32 s71, s71, 9
    s_add_u32 s72, s71, 55296
    v_fma_f32 v40, -v184, v132, v40
    v_fma_f32 v41, -v184, v133, v41
    v_fma_f32 v42, -v184, v134, v42
    v_fma_f32 v43, -v184, v135, v43
    v_pk_mul_f32 v[40:41], v[40:41], v[178:179]
    v_pk_mul_f32 v[42:43], v[42:43], v[178:179]
    v_cvt_pk_bf16_f32 v76, v40, v41
    v_cvt_pk_bf16_f32 v77, v42, v43
    v_lshlrev_b32 v40, 16, v76
    v_and_b32 v41, 0xffff0000, v76
    v_lshlrev_b32 v42, 16, v77
    v_and_b32 v43, 0xffff0000, v77
    v_pk_mul_f32 v[72:73], v[40:41], v[40:41]
    v_pk_mul_f32 v[74:75], v[42:43], v[42:43]
    v_pk_fma_f32 v[72:73], v[72:73], v[236:237], v[238:239]
    v_pk_fma_f32 v[74:75], v[74:75], v[236:237], v[238:239]
    v_pk_mul_f32 v[72:73], v[72:73], v[40:41]
    v_pk_mul_f32 v[74:75], v[74:75], v[42:43]
    v_exp_f32 v72, v72
    v_exp_f32 v73, v73
    v_exp_f32 v74, v74
    v_exp_f32 v75, v75
    s_nop 0
    v_pk_add_f32 v[72:73], v[72:73], v[240:241]
    v_pk_add_f32 v[74:75], v[74:75], v[240:241]
    v_rcp_f32 v72, v72
    v_rcp_f32 v73, v73
    v_rcp_f32 v74, v74
    v_rcp_f32 v75, v75
    s_nop 0
    v_pk_mul_f32 v[40:41], v[40:41], v[72:73]
    v_pk_mul_f32 v[42:43], v[42:43], v[74:75]
    v_cvt_pk_bf16_f32 v88, v40, v41
    v_cvt_pk_bf16_f32 v89, v42, v43
    buffer_store_dwordx2 v[88:89], v235, s[48:51], s71 offen offset:0 sc1
    v_fma_f32 v68, -v185, v132, v68
    v_fma_f32 v69, -v185, v133, v69
    v_fma_f32 v70, -v185, v134, v70
    v_fma_f32 v71, -v185, v135, v71
    v_pk_mul_f32 v[68:69], v[68:69], v[182:183]
    v_pk_mul_f32 v[70:71], v[70:71], v[182:183]
    v_cvt_pk_bf16_f32 v76, v68, v69
    v_cvt_pk_bf16_f32 v77, v70, v71
    v_lshlrev_b32 v68, 16, v76
    v_and_b32 v69, 0xffff0000, v76
    v_lshlrev_b32 v70, 16, v77
    v_and_b32 v71, 0xffff0000, v77
    v_pk_mul_f32 v[72:73], v[68:69], v[68:69]
    v_pk_mul_f32 v[74:75], v[70:71], v[70:71]
    v_pk_fma_f32 v[72:73], v[72:73], v[236:237], v[238:239]
    v_pk_fma_f32 v[74:75], v[74:75], v[236:237], v[238:239]
    v_pk_mul_f32 v[72:73], v[72:73], v[68:69]
    v_pk_mul_f32 v[74:75], v[74:75], v[70:71]
    v_exp_f32 v72, v72
    v_exp_f32 v73, v73
    v_exp_f32 v74, v74
    v_exp_f32 v75, v75
    s_nop 0
    v_pk_add_f32 v[72:73], v[72:73], v[240:241]
    v_pk_add_f32 v[74:75], v[74:75], v[240:241]
    v_rcp_f32 v72, v72
    v_rcp_f32 v73, v73
    v_rcp_f32 v74, v74
    v_rcp_f32 v75, v75
    s_nop 0
    v_pk_mul_f32 v[68:69], v[68:69], v[72:73]
    v_pk_mul_f32 v[70:71], v[70:71], v[74:75]
    v_cvt_pk_bf16_f32 v92, v68, v69
    v_cvt_pk_bf16_f32 v93, v70, v71
    buffer_store_dwordx2 v[92:93], v235, s[48:51], s72 offen offset:0 sc1
    s_lshr_b32 s5, s96, 1
    s_and_b32 s3, s96, 1
    s_and_b32 s6, s97, 7
    s_lshl_b32 s5, s5, 3
    s_add_u32 s77, s5, s6
    s_lshr_b32 s4, s97, 3
    s_lshl_b32 s3, s3, 2
    s_add_u32 s78, s3, s4
    s_lshl_b32 s64, s77, 6
    s_mul_i32 s65, s78, 80
    s_lshl_b32 s14, s77, 3
    s_add_u32 s14, s14, s78
    s_add_u32 s60, s38, 30408704
    s_addc_u32 s61, s39, 0
    s_mov_b32 s62, 8192
    s_mov_b32 s63, 0x00020000
    v_and_b32 v2, 15, v1
    v_lshrrev_b32 v3, 4, v1
    s_mov_b32 s71, s66
    s_mov_b32 s72, 0
    v_lshlrev_b32 v4, 4, v1
    s_mul_i32 s73, s71, 2048
    v_add_u32 v8, s73, v4
    v_lshrrev_b32 v4, 2, v2
    v_and_b32 v5, 1, v3
    v_lshl_add_u32 v4, v5, 2, v4
    v_lshrrev_b32 v5, 1, v3
    v_lshl_add_u32 v4, v5, 4, v4
    v_mul_u32_u24 v4, 160, v4
    v_and_b32 v5, 3, v2
    v_lshl_add_u32 v4, v5, 3, v4
    v_add_u32 v244, 8192, v4
    s_mul_i32 s73, s66, 2816
    s_add_u32 s73, s73, 102400
    v_mul_u32_u24 v4, 176, v2
    v_lshl_add_u32 v4, v3, 3, v4
    v_add_u32 v12, s73, v4
    v_mov_b32 v16, 0
    v_mov_b32 v17, 0
    v_mov_b32 v18, 0
    v_mov_b32 v19, 0
    v_mov_b32 v20, 0
    v_mov_b32 v21, 0
    v_mov_b32 v22, 0
    v_mov_b32 v23, 0
    v_mov_b32 v24, 0
    v_mov_b32 v25, 0
    v_mov_b32 v26, 0
    v_mov_b32 v27, 0
    v_mov_b32 v28, 0
    v_mov_b32 v29, 0
    v_mov_b32 v30, 0
    v_mov_b32 v31, 0
    v_mov_b32 v32, 0
    v_mov_b32 v33, 0
    v_mov_b32 v34, 0
    v_mov_b32 v35, 0
    s_mov_b32 s69, 0
    s_barrier
    ds_read_b128 v[36:39], v8 offset:0
    ds_read_b64_tr_b16 v[40:41], v244 offset:0
    ds_read_b64_tr_b16 v[42:43], v244 offset:1280
    ds_read_b64_tr_b16 v[44:45], v244 offset:32
    ds_read_b64_tr_b16 v[46:47], v244 offset:1312
    ds_read_b64_tr_b16 v[48:49], v244 offset:64
    ds_read_b64_tr_b16 v[50:51], v244 offset:1344
    ds_read_b64_tr_b16 v[52:53], v244 offset:96
    ds_read_b64_tr_b16 v[54:55], v244 offset:1376
    ds_read_b64_tr_b16 v[56:57], v244 offset:128
    ds_read_b64_tr_b16 v[58:59], v244 offset:1408
    s_mov_b32 s70, 9
Lc_15:
    s_waitcnt lgkmcnt(0)
    v_mfma_f32_16x16x32_bf16 v[16:19], v[40:43], v[36:39], v[16:19]
    ds_read_b128 v[60:63], v8 offset:1024
    ds_read_b64_tr_b16 v[64:65], v244 offset:5120
    ds_read_b64_tr_b16 v[66:67], v244 offset:6400
    ds_read_b64_tr_b16 v[68:69], v244 offset:5152
    v_mfma_f32_16x16x32_bf16 v[20:23], v[44:47], v[36:39], v[20:23]
    ds_read_b64_tr_b16 v[70:71], v244 offset:6432
    ds_read_b64_tr_b16 v[72:73], v244 offset:5184
    ds_read_b64_tr_b16 v[74:75], v244 offset:6464
    ds_read_b64_tr_b16 v[76:77], v244 offset:5216
    v_mfma_f32_16x16x32_bf16 v[24:27], v[48:51], v[36:39], v[24:27]
    ds_read_b64_tr_b16 v[78:79], v244 offset:6496
    ds_read_b64_tr_b16 v[80:81], v244 offset:5248
    ds_read_b64_tr_b16 v[82:83], v244 offset:6528
    v_mfma_f32_16x16x32_bf16 v[28:31], v[52:55], v[36:39], v[28:31]
    v_mfma_f32_16x16x32_bf16 v[32:35], v[56:59], v[36:39], v[32:35]
    s_add_u32 s69, s69, 20480
    s_cmp_ge_u32 s69, 102400
    s_cselect_b32 s73, 102400, 0
    s_sub_u32 s69, s69, s73
    s_sub_u32 s73, 20480, s73
    v_add_u32 v8, s73, v8
    v_add_u32 v244, s73, v244
    s_waitcnt lgkmcnt(0)
    v_mfma_f32_16x16x32_bf16 v[16:19], v[64:67], v[60:63], v[16:19]
    ds_read_b128 v[36:39], v8 offset:0
    ds_read_b64_tr_b16 v[40:41], v244 offset:0
    ds_read_b64_tr_b16 v[42:43], v244 offset:1280
    ds_read_b64_tr_b16 v[44:45], v244 offset:32
    v_mfma_f32_16x16x32_bf16 v[20:23], v[68:71], v[60:63], v[20:23]
    ds_read_b64_tr_b16 v[46:47], v244 offset:1312
    ds_read_b64_tr_b16 v[48:49], v244 offset:64
    ds_read_b64_tr_b16 v[50:51], v244 offset:1344
    ds_read_b64_tr_b16 v[52:53], v244 offset:96
    v_mfma_f32_16x16x32_bf16 v[24:27], v[72:75], v[60:63], v[24:27]
    ds_read_b64_tr_b16 v[54:55], v244 offset:1376
    ds_read_b64_tr_b16 v[56:57], v244 offset:128
    ds_read_b64_tr_b16 v[58:59], v244 offset:1408
    v_mfma_f32_16x16x32_bf16 v[28:31], v[76:79], v[60:63], v[28:31]
    v_mfma_f32_16x16x32_bf16 v[32:35], v[80:83], v[60:63], v[32:35]
    s_cmp_lg_u32 s70, 7
    s_cbranch_scc1 Ldr_16
    s_waitcnt vmcnt(0)
Ldr_16:
    s_cmp_lg_u32 s70, 6
    s_cbranch_scc1 Lmid_17
    v_lshlrev_b32 v4, 2, v2
    s_lshl_b32 s71, s66, 4
    s_add_u32 s71, s71, s64
    s_lshl_b32 s71, s71, 2
    buffer_load_dword v220, v4, s[60:63], s71 offen sc1
Lmid_17:
    s_barrier
    s_sub_u32 s70, s70, 1
    s_cmp_lg_u32 s70, 0
    s_cbranch_scc1 Lc_15
    s_waitcnt lgkmcnt(0)
    v_mfma_f32_16x16x32_bf16 v[16:19], v[40:43], v[36:39], v[16:19]
    ds_read_b128 v[60:63], v8 offset:1024
    ds_read_b64_tr_b16 v[64:65], v244 offset:5120
    ds_read_b64_tr_b16 v[66:67], v244 offset:6400
    ds_read_b64_tr_b16 v[68:69], v244 offset:5152
    v_mfma_f32_16x16x32_bf16 v[20:23], v[44:47], v[36:39], v[20:23]
    ds_read_b64_tr_b16 v[70:71], v244 offset:6432
    ds_read_b64_tr_b16 v[72:73], v244 offset:5184
    ds_read_b64_tr_b16 v[74:75], v244 offset:6464
    ds_read_b64_tr_b16 v[76:77], v244 offset:5216
    v_mfma_f32_16x16x32_bf16 v[24:27], v[48:51], v[36:39], v[24:27]
    ds_read_b64_tr_b16 v[78:79], v244 offset:6496
    ds_read_b64_tr_b16 v[80:81], v244 offset:5248
    ds_read_b64_tr_b16 v[82:83], v244 offset:6528
    v_mfma_f32_16x16x32_bf16 v[28:31], v[52:55], v[36:39], v[28:31]
    v_mfma_f32_16x16x32_bf16 v[32:35], v[56:59], v[36:39], v[32:35]
    s_waitcnt lgkmcnt(0)
    v_mfma_f32_16x16x32_bf16 v[16:19], v[64:67], v[60:63], v[16:19]
    v_mfma_f32_16x16x32_bf16 v[20:23], v[68:71], v[60:63], v[20:23]
    v_mfma_f32_16x16x32_bf16 v[24:27], v[72:75], v[60:63], v[24:27]
    v_mfma_f32_16x16x32_bf16 v[28:31], v[76:79], v[60:63], v[28:31]
    v_mfma_f32_16x16x32_bf16 v[32:35], v[80:83], v[60:63], v[32:35]
    s_nop 9
    v_cvt_pk_bf16_f32 v210, v16, v17
    v_cvt_pk_bf16_f32 v211, v18, v19
    v_cvt_pk_bf16_f32 v212, v20, v21
    v_cvt_pk_bf16_f32 v213, v22, v23
    v_cvt_pk_bf16_f32 v214, v24, v25
    v_cvt_pk_bf16_f32 v215, v26, v27
    v_cvt_pk_bf16_f32 v216, v28, v29
    v_cvt_pk_bf16_f32 v217, v30, v31
    v_cvt_pk_bf16_f32 v218, v32, v33
    v_cvt_pk_bf16_f32 v219, v34, v35
    s_lshr_b32 s5, s96, 1
    s_and_b32 s3, s96, 1
    s_and_b32 s6, s97, 7
    s_lshl_b32 s5, s5, 3
    s_add_u32 s77, s5, s6
    s_lshr_b32 s4, s97, 3
    s_lshl_b32 s3, s3, 2
    s_add_u32 s78, s3, s4
    s_lshl_b32 s64, s77, 6
    s_mul_i32 s65, s78, 80
    s_lshl_b32 s14, s77, 3
    s_add_u32 s14, s14, s78
    s_mov_b32 s48, s34
    s_mov_b32 s49, s35
    s_mov_b32 s50, 2621440
    s_mov_b32 s51, 0x00020000
    s_mov_b32 s71, s66
    s_mov_b32 s72, 0
    s_mul_i32 s73, s71, 16
    s_add_u32 s73, s73, s64
    s_mul_i32 s73, s73, 1280
    s_mul_i32 s74, s72, 80
    s_add_u32 s74, s74, s65
    s_lshl_b32 s72, s74, 1
    s_add_u32 s73, s73, s72
    s_mul_i32 s71, s66, 2816
    s_add_u32 s71, s71, 102400
    s_mov_b32 s72, 1280
    v_lshrrev_b32 v5, 4, v1
    v_and_b32 v6, 15, v1
    v_mul_u32_u24 v7, 176, v5
    v_lshl_add_u32 v7, v6, 4, v7
    v_add_u32 v232, s71, v7
    v_cmp_gt_u32 vcc, 10, v6
    v_lshlrev_b32 v6, 4, v6
    v_mad_u32_u24 v7, v5, s72, v6
    v_add_u32 v233, s73, v7
    v_bfrev_b32 v7, 1
    v_cndmask_b32 v233, v7, v233, vcc
    v_and_b32 v2, 15, v1
    v_lshrrev_b32 v3, 4, v1
    s_mov_b32 s71, s66
    s_mov_b32 s72, 0
    v_lshlrev_b32 v4, 4, v1
    s_mul_i32 s73, s71, 2048
    v_add_u32 v8, s73, v4
    v_lshrrev_b32 v4, 2, v2
    v_and_b32 v5, 1, v3
    v_lshl_add_u32 v4, v5, 2, v4
    v_lshrrev_b32 v5, 1, v3
    v_lshl_add_u32 v4, v5, 4, v4
    v_mul_u32_u24 v4, 160, v4
    v_and_b32 v5, 3, v2
    v_lshl_add_u32 v4, v5, 3, v4
    v_add_u32 v244, 8192, v4
    s_mul_i32 s73, s66, 2816
    s_add_u32 s73, s73, 102400
    v_mul_u32_u24 v4, 176, v2
    v_lshl_add_u32 v4, v3, 3, v4
    v_add_u32 v12, s73, v4
    v_mov_b32 v16, 0
    v_mov_b32 v17, 0
    v_mov_b32 v18, 0
    v_mov_b32 v19, 0
    v_mov_b32 v20, 0
    v_mov_b32 v21, 0
    v_mov_b32 v22, 0
    v_mov_b32 v23, 0
    v_mov_b32 v24, 0
    v_mov_b32 v25, 0
    v_mov_b32 v26, 0
    v_mov_b32 v27, 0
    v_mov_b32 v28, 0
    v_mov_b32 v29, 0
    v_mov_b32 v30, 0
    v_mov_b32 v31, 0
    v_mov_b32 v32, 0
    v_mov_b32 v33, 0
    v_mov_b32 v34, 0
    v_mov_b32 v35, 0
    s_mov_b32 s69, 0
    s_barrier
    ds_read_b128 v[36:39], v8 offset:0
    ds_read_b64_tr_b16 v[40:41], v244 offset:0
    ds_read_b64_tr_b16 v[42:43], v244 offset:1280
    ds_read_b64_tr_b16 v[44:45], v244 offset:32
    ds_read_b64_tr_b16 v[46:47], v244 offset:1312
    ds_read_b64_tr_b16 v[48:49], v244 offset:64
    ds_read_b64_tr_b16 v[50:51], v244 offset:1344
    ds_read_b64_tr_b16 v[52:53], v244 offset:96
    ds_read_b64_tr_b16 v[54:55], v244 offset:1376
    ds_read_b64_tr_b16 v[56:57], v244 offset:128
    ds_read_b64_tr_b16 v[58:59], v244 offset:1408
    s_mov_b32 s70, 26
Lc_18:
    s_waitcnt lgkmcnt(0)
    v_mfma_f32_16x16x32_bf16 v[16:19], v[40:43], v[36:39], v[16:19]
    ds_read_b128 v[60:63], v8 offset:1024
    ds_read_b64_tr_b16 v[64:65], v244 offset:5120
    ds_read_b64_tr_b16 v[66:67], v244 offset:6400
    ds_read_b64_tr_b16 v[68:69], v244 offset:5152
    v_mfma_f32_16x16x32_bf16 v[20:23], v[44:47], v[36:39], v[20:23]
    ds_read_b64_tr_b16 v[70:71], v244 offset:6432
    ds_read_b64_tr_b16 v[72:73], v244 offset:5184
    ds_read_b64_tr_b16 v[74:75], v244 offset:6464
    ds_read_b64_tr_b16 v[76:77], v244 offset:5216
    v_mfma_f32_16x16x32_bf16 v[24:27], v[48:51], v[36:39], v[24:27]
    ds_read_b64_tr_b16 v[78:79], v244 offset:6496
    ds_read_b64_tr_b16 v[80:81], v244 offset:5248
    ds_read_b64_tr_b16 v[82:83], v244 offset:6528
    v_mfma_f32_16x16x32_bf16 v[28:31], v[52:55], v[36:39], v[28:31]
    v_mfma_f32_16x16x32_bf16 v[32:35], v[56:59], v[36:39], v[32:35]
    s_add_u32 s69, s69, 20480
    s_cmp_ge_u32 s69, 163840
    s_cselect_b32 s73, 163840, 0
    s_sub_u32 s69, s69, s73
    s_sub_u32 s73, 20480, s73
    v_add_u32 v8, s73, v8
    v_add_u32 v244, s73, v244
    s_waitcnt lgkmcnt(0)
    v_mfma_f32_16x16x32_bf16 v[16:19], v[64:67], v[60:63], v[16:19]
    ds_read_b128 v[36:39], v8 offset:0
    ds_read_b64_tr_b16 v[40:41], v244 offset:0
    ds_read_b64_tr_b16 v[42:43], v244 offset:1280
    ds_read_b64_tr_b16 v[44:45], v244 offset:32
    v_mfma_f32_16x16x32_bf16 v[20:23], v[68:71], v[60:63], v[20:23]
    ds_read_b64_tr_b16 v[46:47], v244 offset:1312
    ds_read_b64_tr_b16 v[48:49], v244 offset:64
    ds_read_b64_tr_b16 v[50:51], v244 offset:1344
    ds_read_b64_tr_b16 v[52:53], v244 offset:96
    v_mfma_f32_16x16x32_bf16 v[24:27], v[72:75], v[60:63], v[24:27]
    ds_read_b64_tr_b16 v[54:55], v244 offset:1376
    ds_read_b64_tr_b16 v[56:57], v244 offset:128
    ds_read_b64_tr_b16 v[58:59], v244 offset:1408
    v_mfma_f32_16x16x32_bf16 v[28:31], v[76:79], v[60:63], v[28:31]
    v_mfma_f32_16x16x32_bf16 v[32:35], v[80:83], v[60:63], v[32:35]
    s_barrier
    s_sub_u32 s70, s70, 1
    s_cmp_lg_u32 s70, 0
    s_cbranch_scc1 Lc_18
    s_waitcnt lgkmcnt(0)
    v_mfma_f32_16x16x32_bf16 v[16:19], v[40:43], v[36:39], v[16:19]
    ds_read_b128 v[60:63], v8 offset:1024
    ds_read_b64_tr_b16 v[64:65], v244 offset:5120
    ds_read_b64_tr_b16 v[66:67], v244 offset:6400
    ds_read_b64_tr_b16 v[68:69], v244 offset:5152
    v_mfma_f32_16x16x32_bf16 v[20:23], v[44:47], v[36:39], v[20:23]
    ds_read_b64_tr_b16 v[70:71], v244 offset:6432
    ds_read_b64_tr_b16 v[72:73], v244 offset:5184
    ds_read_b64_tr_b16 v[74:75], v244 offset:6464
    ds_read_b64_tr_b16 v[76:77], v244 offset:5216
    v_mfma_f32_16x16x32_bf16 v[24:27], v[48:51], v[36:39], v[24:27]
    ds_read_b64_tr_b16 v[78:79], v244 offset:6496
    ds_read_b64_tr_b16 v[80:81], v244 offset:5248
    ds_read_b64_tr_b16 v[82:83], v244 offset:6528
    v_mfma_f32_16x16x32_bf16 v[28:31], v[52:55], v[36:39], v[28:31]
    v_mfma_f32_16x16x32_bf16 v[32:35], v[56:59], v[36:39], v[32:35]
    s_waitcnt lgkmcnt(0)
    v_mfma_f32_16x16x32_bf16 v[16:19], v[64:67], v[60:63], v[16:19]
    v_mfma_f32_16x16x32_bf16 v[20:23], v[68:71], v[60:63], v[20:23]
    v_mfma_f32_16x16x32_bf16 v[24:27], v[72:75], v[60:63], v[24:27]
    v_mfma_f32_16x16x32_bf16 v[28:31], v[76:79], v[60:63], v[28:31]
    v_mfma_f32_16x16x32_bf16 v[32:35], v[80:83], v[60:63], v[32:35]
    s_nop 9
    s_waitcnt vmcnt(0)
    v_sub_f32 v48, 1.0, v220
    v_cvt_pk_bf16_f32 v48, v48, v48
    v_lshlrev_b32 v48, 16, v48
    v_mov_b32 v49, v48
    v_mov_b32 v50, v220
    v_mov_b32 v51, v220
    v_cvt_pk_bf16_f32 v44, v16, v17
    v_cvt_pk_bf16_f32 v45, v18, v19
    v_lshlrev_b32 v16, 16, v44
    v_and_b32 v17, 0xffff0000, v44
    v_lshlrev_b32 v18, 16, v45
    v_and_b32 v19, 0xffff0000, v45
    v_lshlrev_b32 v36, 16, v200
    v_and_b32 v37, 0xffff0000, v200
    v_lshlrev_b32 v38, 16, v201
    v_and_b32 v39, 0xffff0000, v201
    v_pk_add_f32 v[16:17], v[16:17], v[36:37]
    v_pk_add_f32 v[18:19], v[18:19], v[38:39]
    v_cvt_pk_bf16_f32 v44, v16, v17
    v_cvt_pk_bf16_f32 v45, v18, v19
    v_lshlrev_b32 v16, 16, v44
    v_and_b32 v17, 0xffff0000, v44
    v_lshlrev_b32 v18, 16, v45
    v_and_b32 v19, 0xffff0000, v45
    v_pk_mul_f32 v[16:17], v[16:17], v[48:49]
    v_pk_mul_f32 v[18:19], v[18:19], v[48:49]
    v_cvt_pk_bf16_f32 v44, v16, v17
    v_cvt_pk_bf16_f32 v45, v18, v19
    v_lshlrev_b32 v16, 16, v44
    v_and_b32 v17, 0xffff0000, v44
    v_lshlrev_b32 v18, 16, v45
    v_and_b32 v19, 0xffff0000, v45
    v_lshlrev_b32 v36, 16, v210
    v_and_b32 v37, 0xffff0000, v210
    v_lshlrev_b32 v38, 16, v211
    v_and_b32 v39, 0xffff0000, v211
    v_pk_mul_f32 v[36:37], v[36:37], v[50:51]
    v_pk_mul_f32 v[38:39], v[38:39], v[50:51]
    v_cvt_pk_bf16_f32 v44, v36, v37
    v_cvt_pk_bf16_f32 v45, v38, v39
    v_lshlrev_b32 v36, 16, v44
    v_and_b32 v37, 0xffff0000, v44
    v_lshlrev_b32 v38, 16, v45
    v_and_b32 v39, 0xffff0000, v45
    v_pk_add_f32 v[16:17], v[16:17], v[36:37]
    v_pk_add_f32 v[18:19], v[18:19], v[38:39]
    v_cvt_pk_bf16_f32 v52, v16, v17
    v_cvt_pk_bf16_f32 v53, v18, v19
    ds_write_b64 v12, v[52:53] offset:0
    v_cvt_pk_bf16_f32 v44, v20, v21
    v_cvt_pk_bf16_f32 v45, v22, v23
    v_lshlrev_b32 v20, 16, v44
    v_and_b32 v21, 0xffff0000, v44
    v_lshlrev_b32 v22, 16, v45
    v_and_b32 v23, 0xffff0000, v45
    v_lshlrev_b32 v36, 16, v202
    v_and_b32 v37, 0xffff0000, v202
    v_lshlrev_b32 v38, 16, v203
    v_and_b32 v39, 0xffff0000, v203
    v_pk_add_f32 v[20:21], v[20:21], v[36:37]
    v_pk_add_f32 v[22:23], v[22:23], v[38:39]
    v_cvt_pk_bf16_f32 v44, v20, v21
    v_cvt_pk_bf16_f32 v45, v22, v23
    v_lshlrev_b32 v20, 16, v44
    v_and_b32 v21, 0xffff0000, v44
    v_lshlrev_b32 v22, 16, v45
    v_and_b32 v23, 0xffff0000, v45
    v_pk_mul_f32 v[20:21], v[20:21], v[48:49]
    v_pk_mul_f32 v[22:23], v[22:23], v[48:49]
    v_cvt_pk_bf16_f32 v44, v20, v21
    v_cvt_pk_bf16_f32 v45, v22, v23
    v_lshlrev_b32 v20, 16, v44
    v_and_b32 v21, 0xffff0000, v44
    v_lshlrev_b32 v22, 16, v45
    v_and_b32 v23, 0xffff0000, v45
    v_lshlrev_b32 v36, 16, v212
    v_and_b32 v37, 0xffff0000, v212
    v_lshlrev_b32 v38, 16, v213
    v_and_b32 v39, 0xffff0000, v213
    v_pk_mul_f32 v[36:37], v[36:37], v[50:51]
    v_pk_mul_f32 v[38:39], v[38:39], v[50:51]
    v_cvt_pk_bf16_f32 v44, v36, v37
    v_cvt_pk_bf16_f32 v45, v38, v39
    v_lshlrev_b32 v36, 16, v44
    v_and_b32 v37, 0xffff0000, v44
    v_lshlrev_b32 v38, 16, v45
    v_and_b32 v39, 0xffff0000, v45
    v_pk_add_f32 v[20:21], v[20:21], v[36:37]
    v_pk_add_f32 v[22:23], v[22:23], v[38:39]
    v_cvt_pk_bf16_f32 v54, v20, v21
    v_cvt_pk_bf16_f32 v55, v22, v23
    ds_write_b64 v12, v[54:55] offset:32
    v_cvt_pk_bf16_f32 v44, v24, v25
    v_cvt_pk_bf16_f32 v45, v26, v27
    v_lshlrev_b32 v24, 16, v44
    v_and_b32 v25, 0xffff0000, v44
    v_lshlrev_b32 v26, 16, v45
    v_and_b32 v27, 0xffff0000, v45
    v_lshlrev_b32 v36, 16, v204
    v_and_b32 v37, 0xffff0000, v204
    v_lshlrev_b32 v38, 16, v205
    v_and_b32 v39, 0xffff0000, v205
    v_pk_add_f32 v[24:25], v[24:25], v[36:37]
    v_pk_add_f32 v[26:27], v[26:27], v[38:39]
    v_cvt_pk_bf16_f32 v44, v24, v25
    v_cvt_pk_bf16_f32 v45, v26, v27
    v_lshlrev_b32 v24, 16, v44
    v_and_b32 v25, 0xffff0000, v44
    v_lshlrev_b32 v26, 16, v45
    v_and_b32 v27, 0xffff0000, v45
    v_pk_mul_f32 v[24:25], v[24:25], v[48:49]
    v_pk_mul_f32 v[26:27], v[26:27], v[48:49]
    v_cvt_pk_bf16_f32 v44, v24, v25
    v_cvt_pk_bf16_f32 v45, v26, v27
    v_lshlrev_b32 v24, 16, v44
    v_and_b32 v25, 0xffff0000, v44
    v_lshlrev_b32 v26, 16, v45
    v_and_b32 v27, 0xffff0000, v45
    v_lshlrev_b32 v36, 16, v214
    v_and_b32 v37, 0xffff0000, v214
    v_lshlrev_b32 v38, 16, v215
    v_and_b32 v39, 0xffff0000, v215
    v_pk_mul_f32 v[36:37], v[36:37], v[50:51]
    v_pk_mul_f32 v[38:39], v[38:39], v[50:51]
    v_cvt_pk_bf16_f32 v44, v36, v37
    v_cvt_pk_bf16_f32 v45, v38, v39
    v_lshlrev_b32 v36, 16, v44
    v_and_b32 v37, 0xffff0000, v44
    v_lshlrev_b32 v38, 16, v45
    v_and_b32 v39, 0xffff0000, v45
    v_pk_add_f32 v[24:25], v[24:25], v[36:37]
    v_pk_add_f32 v[26:27], v[26:27], v[38:39]
    v_cvt_pk_bf16_f32 v56, v24, v25
    v_cvt_pk_bf16_f32 v57, v26, v27
    ds_write_b64 v12, v[56:57] offset:64
    v_cvt_pk_bf16_f32 v44, v28, v29
    v_cvt_pk_bf16_f32 v45, v30, v31
    v_lshlrev_b32 v28, 16, v44
    v_and_b32 v29, 0xffff0000, v44
    v_lshlrev_b32 v30, 16, v45
    v_and_b32 v31, 0xffff0000, v45
    v_lshlrev_b32 v36, 16, v206
    v_and_b32 v37, 0xffff0000, v206
    v_lshlrev_b32 v38, 16, v207
    v_and_b32 v39, 0xffff0000, v207
    v_pk_add_f32 v[28:29], v[28:29], v[36:37]
    v_pk_add_f32 v[30:31], v[30:31], v[38:39]
    v_cvt_pk_bf16_f32 v44, v28, v29
    v_cvt_pk_bf16_f32 v45, v30, v31
    v_lshlrev_b32 v28, 16, v44
    v_and_b32 v29, 0xffff0000, v44
    v_lshlrev_b32 v30, 16, v45
    v_and_b32 v31, 0xffff0000, v45
    v_pk_mul_f32 v[28:29], v[28:29], v[48:49]
    v_pk_mul_f32 v[30:31], v[30:31], v[48:49]
    v_cvt_pk_bf16_f32 v44, v28, v29
    v_cvt_pk_bf16_f32 v45, v30, v31
    v_lshlrev_b32 v28, 16, v44
    v_and_b32 v29, 0xffff0000, v44
    v_lshlrev_b32 v30, 16, v45
    v_and_b32 v31, 0xffff0000, v45
    v_lshlrev_b32 v36, 16, v216
    v_and_b32 v37, 0xffff0000, v216
    v_lshlrev_b32 v38, 16, v217
    v_and_b32 v39, 0xffff0000, v217
    v_pk_mul_f32 v[36:37], v[36:37], v[50:51]
    v_pk_mul_f32 v[38:39], v[38:39], v[50:51]
    v_cvt_pk_bf16_f32 v44, v36, v37
    v_cvt_pk_bf16_f32 v45, v38, v39
    v_lshlrev_b32 v36, 16, v44
    v_and_b32 v37, 0xffff0000, v44
    v_lshlrev_b32 v38, 16, v45
    v_and_b32 v39, 0xffff0000, v45
    v_pk_add_f32 v[28:29], v[28:29], v[36:37]
    v_pk_add_f32 v[30:31], v[30:31], v[38:39]
    v_cvt_pk_bf16_f32 v58, v28, v29
    v_cvt_pk_bf16_f32 v59, v30, v31
    ds_write_b64 v12, v[58:59] offset:96
    v_cvt_pk_bf16_f32 v44, v32, v33
    v_cvt_pk_bf16_f32 v45, v34, v35
    v_lshlrev_b32 v32, 16, v44
    v_and_b32 v33, 0xffff0000, v44
    v_lshlrev_b32 v34, 16, v45
    v_and_b32 v35, 0xffff0000, v45
    v_lshlrev_b32 v36, 16, v208
    v_and_b32 v37, 0xffff0000, v208
    v_lshlrev_b32 v38, 16, v209
    v_and_b32 v39, 0xffff0000, v209
    v_pk_add_f32 v[32:33], v[32:33], v[36:37]
    v_pk_add_f32 v[34:35], v[34:35], v[38:39]
    v_cvt_pk_bf16_f32 v44, v32, v33
    v_cvt_pk_bf16_f32 v45, v34, v35
    v_lshlrev_b32 v32, 16, v44
    v_and_b32 v33, 0xffff0000, v44
    v_lshlrev_b32 v34, 16, v45
    v_and_b32 v35, 0xffff0000, v45
    v_pk_mul_f32 v[32:33], v[32:33], v[48:49]
    v_pk_mul_f32 v[34:35], v[34:35], v[48:49]
    v_cvt_pk_bf16_f32 v44, v32, v33
    v_cvt_pk_bf16_f32 v45, v34, v35
    v_lshlrev_b32 v32, 16, v44
    v_and_b32 v33, 0xffff0000, v44
    v_lshlrev_b32 v34, 16, v45
    v_and_b32 v35, 0xffff0000, v45
    v_lshlrev_b32 v36, 16, v218
    v_and_b32 v37, 0xffff0000, v218
    v_lshlrev_b32 v38, 16, v219
    v_and_b32 v39, 0xffff0000, v219
    v_pk_mul_f32 v[36:37], v[36:37], v[50:51]
    v_pk_mul_f32 v[38:39], v[38:39], v[50:51]
    v_cvt_pk_bf16_f32 v44, v36, v37
    v_cvt_pk_bf16_f32 v45, v38, v39
    v_lshlrev_b32 v36, 16, v44
    v_and_b32 v37, 0xffff0000, v44
    v_lshlrev_b32 v38, 16, v45
    v_and_b32 v39, 0xffff0000, v45
    v_pk_add_f32 v[32:33], v[32:33], v[36:37]
    v_pk_add_f32 v[34:35], v[34:35], v[38:39]
    v_cvt_pk_bf16_f32 v52, v32, v33
    v_cvt_pk_bf16_f32 v53, v34, v35
    ds_write_b64 v12, v[52:53] offset:128
    s_waitcnt lgkmcnt(0)
    ds_read_b128 v[60:63], v232 offset:0
    ds_read_b128 v[64:67], v232 offset:704
    ds_read_b128 v[68:71], v232 offset:1408
    ds_read_b128 v[72:75], v232 offset:2112
    s_waitcnt lgkmcnt(3)
    buffer_store_dwordx4 v[60:63], v233, s[48:51], 0 offen
    s_waitcnt lgkmcnt(2)
    s_mov_b32 s88, 5120
    buffer_store_dwordx4 v[64:67], v233, s[48:51], s88 offen
    s_waitcnt lgkmcnt(1)
    s_mov_b32 s88, 10240
    buffer_store_dwordx4 v[68:71], v233, s[48:51], s88 offen
    s_waitcnt lgkmcnt(0)
    s_mov_b32 s88, 15360
    buffer_store_dwordx4 v[72:75], v233, s[48:51], s88 offen
    s_endpgm
Lcold_L1:
    s_lshr_b32 s5, s96, 1
    s_and_b32 s3, s96, 1
    s_and_b32 s6, s97, 7
    s_lshl_b32 s5, s5, 3
    s_add_u32 s77, s5, s6
    s_lshr_b32 s4, s97, 3
    s_lshl_b32 s3, s3, 2
    s_add_u32 s78, s3, s4
    s_lshl_b32 s64, s77, 6
    s_mul_i32 s65, s78, 80
    s_lshl_b32 s14, s77, 3
    s_add_u32 s14, s14, s78
    v_lshrrev_b32 v2, 3, v1
    v_and_b32 v3, 7, v1
    s_mul_i32 s72, s79, 16
    s_mov_b32 s73, 1280
    v_add3_u32 v4, v2, s72, 0
    v_bfe_u32 v5, v4, 1, 3
    v_xor_b32 v5, v5, v3
    v_lshlrev_b32 v5, 4, v5
    v_add_u32 v4, s64, v4
    v_mad_u32_u24 v176, v4, s73, v5
    v_add3_u32 v4, v2, s72, 8
    v_bfe_u32 v5, v4, 1, 3
    v_xor_b32 v5, v5, v3
    v_lshlrev_b32 v5, 4, v5
    v_add_u32 v4, s64, v4
    v_mad_u32_u24 v177, v4, s73, v5
    s_mul_i32 s72, s79, 192
    s_lshl_b32 s74, s65, 1
    s_mov_b32 s73, 5462
    s_mov_b32 s71, 1280
    v_bfrev_b32 v7, 1
    v_add_u32 v4, s72, v1
    v_mul_u32_u24 v5, s73, v4
    v_lshrrev_b32 v5, 16, v5
    v_mul_u32_u24 v6, 12, v5
    v_sub_u32 v4, v4, v6
    v_bfe_u32 v6, v5, 3, 1
    v_lshlrev_b32 v6, 1, v6
    v_xor_b32 v4, v4, v6
    v_cmp_gt_u32 vcc, 10, v4
    v_lshlrev_b32 v4, 4, v4
    v_add_u32 v4, s74, v4
    v_mad_u32_u24 v184, v5, s71, v4
    v_cndmask_b32 v184, v7, v184, vcc
    v_add_u32 v4, s72, v1
    v_add_u32 v4, 64, v4
    v_mul_u32_u24 v5, s73, v4
    v_lshrrev_b32 v5, 16, v5
    v_mul_u32_u24 v6, 12, v5
    v_sub_u32 v4, v4, v6
    v_bfe_u32 v6, v5, 3, 1
    v_lshlrev_b32 v6, 1, v6
    v_xor_b32 v4, v4, v6
    v_cmp_gt_u32 vcc, 10, v4
    v_lshlrev_b32 v4, 4, v4
    v_add_u32 v4, s74, v4
    v_mad_u32_u24 v185, v5, s71, v4
    v_cndmask_b32 v185, v7, v185, vcc
    v_add_u32 v4, s72, v1
    v_add_u32 v4, 128, v4
    v_mul_u32_u24 v5, s73, v4
    v_lshrrev_b32 v5, 16, v5
    v_mul_u32_u24 v6, 12, v5
    v_sub_u32 v4, v4, v6
    v_bfe_u32 v6, v5, 3, 1
    v_lshlrev_b32 v6, 1, v6
    v_xor_b32 v4, v4, v6
    v_cmp_gt_u32 vcc, 10, v4
    v_lshlrev_b32 v4, 4, v4
    v_add_u32 v4, s74, v4
    v_mad_u32_u24 v186, v5, s71, v4
    v_cndmask_b32 v186, v7, v186, vcc
    s_mul_i32 s75, s79, 2048
    s_mul_i32 s76, s79, 3072
    s_add_u32 s76, s76, 8192
    s_mov_b32 s67, 0
    s_mov_b32 s68, 0
    s_waitcnt lgkmcnt(0)
    s_mov_b32 s40, s16
    s_mov_b32 s41, s17
    s_mov_b32 s42, 2621440
    s_mov_b32 s43, 0x00020000
    s_mov_b32 s44, s24
    s_mov_b32 s45, s25
    s_mov_b32 s46, 819200
    s_mov_b32 s47, 0x00020000
    s_mov_b32 s70, 4
Liss_19:
    s_add_u32 m0, s75, 0
    s_nop 0
    buffer_load_dwordx4 v176, s[40:43], s67 offen lds
    s_add_u32 m0, s75, 1024
    s_nop 0
    buffer_load_dwordx4 v177, s[40:43], s67 offen lds
    s_add_u32 m0, s76, 0
    s_nop 0
    buffer_load_dwordx4 v184, s[44:47], s68 offen lds
    s_add_u32 m0, s76, 1024
    s_nop 0
    buffer_load_dwordx4 v185, s[44:47], s68 offen lds
    s_add_u32 m0, s76, 2048
    s_nop 0
    buffer_load_dwordx4 v186, s[44:47], s68 offen lds
    s_add_u32 s67, s67, 128
    s_add_u32 s68, s68, 81920
    s_add_u32 s75, s75, 20480
    s_add_u32 s76, s76, 20480
    s_cmp_ge_u32 s75, 102400
    s_cselect_b32 s69, 102400, 0
    s_sub_u32 s75, s75, s69
    s_sub_u32 s76, s76, s69
    s_sub_u32 s70, s70, 1
    s_cmp_lg_u32 s70, 0
    s_cbranch_scc1 Liss_19
    s_mov_b32 s7, s15
    s_mov_b32 s15, s14
    s_waitcnt vmcnt(10)
    s_barrier
    s_add_u32 m0, s75, 0
    s_nop 0
    buffer_load_dwordx4 v176, s[40:43], s67 offen lds
    s_add_u32 m0, s75, 1024
    s_nop 0
    buffer_load_dwordx4 v177, s[40:43], s67 offen lds
    s_add_u32 m0, s76, 0
    s_nop 0
    buffer_load_dwordx4 v184, s[44:47], s68 offen lds
    s_add_u32 m0, s76, 1024
    s_nop 0
    buffer_load_dwordx4 v185, s[44:47], s68 offen lds
    s_add_u32 m0, s76, 2048
    s_nop 0
    buffer_load_dwordx4 v186, s[44:47], s68 offen lds
    s_add_u32 s67, s67, 128
    s_add_u32 s68, s68, 81920
    s_add_u32 s75, s75, 20480
    s_add_u32 s76, s76, 20480
    s_cmp_ge_u32 s75, 102400
    s_cselect_b32 s69, 102400, 0
    s_sub_u32 s75, s75, s69
    s_sub_u32 s76, s76, s69
    s_mov_b32 s70, 5
Lldm_20:
    s_waitcnt vmcnt(10)
    s_barrier
    s_add_u32 m0, s75, 0
    s_nop 0
    buffer_load_dwordx4 v176, s[40:43], s67 offen lds
    s_add_u32 m0, s75, 1024
    s_nop 0
    buffer_load_dwordx4 v177, s[40:43], s67 offen lds
    s_add_u32 m0, s76, 0
    s_nop 0
    buffer_load_dwordx4 v184, s[44:47], s68 offen lds
    s_add_u32 m0, s76, 1024
    s_nop 0
    buffer_load_dwordx4 v185, s[44:47], s68 offen lds
    s_add_u32 m0, s76, 2048
    s_nop 0
    buffer_load_dwordx4 v186, s[44:47], s68 offen lds
    s_add_u32 s67, s67, 128
    s_add_u32 s68, s68, 81920
    s_add_u32 s75, s75, 20480
    s_add_u32 s76, s76, 20480
    s_cmp_ge_u32 s75, 102400
    s_cselect_b32 s69, 102400, 0
    s_sub_u32 s75, s75, s69
    s_sub_u32 s76, s76, s69
    s_sub_u32 s70, s70, 1
    s_cmp_lg_u32 s70, 0
    s_cbranch_scc1 Lldm_20
    s_lshr_b32 s5, s96, 2
    s_and_b32 s3, s96, 3
    s_and_b32 s6, s97, 7
    s_lshl_b32 s5, s5, 3
    s_add_u32 s77, s5, s6
    s_lshr_b32 s4, s97, 3
    s_lshl_b32 s4, s4, 2
    s_add_u32 s78, s4, s3
    s_lshl_b32 s14, s77, 4
    s_add_u32 s14, s14, s78
    s_add_u32 s14, s14, 256
    s_min_u32 s78, s78, 14
    s_lshl_b32 s64, s77, 7
    s_lshl_b32 s65, s78, 7
    v_lshrrev_b32 v2, 3, v1
    v_and_b32 v3, 7, v1
    s_mul_i32 s72, s79, 32
    s_mov_b32 s73, 1280
    v_add3_u32 v4, v2, s72, 0
    v_bfe_u32 v5, v4, 1, 3
    v_xor_b32 v5, v5, v3
    v_lshlrev_b32 v5, 4, v5
    v_add_u32 v4, s64, v4
    v_mad_u32_u24 v176, v4, s73, v5
    v_add3_u32 v4, v2, s72, 8
    v_bfe_u32 v5, v4, 1, 3
    v_xor_b32 v5, v5, v3
    v_lshlrev_b32 v5, 4, v5
    v_add_u32 v4, s64, v4
    v_mad_u32_u24 v177, v4, s73, v5
    v_add3_u32 v4, v2, s72, 16
    v_bfe_u32 v5, v4, 1, 3
    v_xor_b32 v5, v5, v3
    v_lshlrev_b32 v5, 4, v5
    v_add_u32 v4, s64, v4
    v_mad_u32_u24 v178, v4, s73, v5
    v_add3_u32 v4, v2, s72, 24
    v_bfe_u32 v5, v4, 1, 3
    v_xor_b32 v5, v5, v3
    v_lshlrev_b32 v5, 4, v5
    v_add_u32 v4, s64, v4
    v_mad_u32_u24 v179, v4, s73, v5
    s_mul_i32 s72, s79, 256
    s_lshl_b32 s74, s65, 1
    s_mov_b32 s73, 4096
    s_mov_b32 s71, 3840
    v_bfrev_b32 v7, 1
    v_add_u32 v4, s72, v1
    v_mul_u32_u24 v5, s73, v4
    v_lshrrev_b32 v5, 16, v5
    v_mul_u32_u24 v6, 16, v5
    v_sub_u32 v4, v4, v6
    v_bfe_u32 v6, v5, 0, 1
    v_lshlrev_b32 v6, 1, v6
    v_xor_b32 v4, v4, v6
    v_bfe_u32 v6, v5, 1, 1
    v_lshlrev_b32 v6, 2, v6
    v_xor_b32 v4, v4, v6
    v_bfe_u32 v6, v5, 3, 1
    v_lshlrev_b32 v6, 3, v6
    v_xor_b32 v4, v4, v6
    v_lshlrev_b32 v4, 4, v4
    v_add_u32 v4, s74, v4
    v_mad_u32_u24 v184, v5, s71, v4
    v_add_u32 v4, s72, v1
    v_add_u32 v4, 64, v4
    v_mul_u32_u24 v5, s73, v4
    v_lshrrev_b32 v5, 16, v5
    v_mul_u32_u24 v6, 16, v5
    v_sub_u32 v4, v4, v6
    v_bfe_u32 v6, v5, 0, 1
    v_lshlrev_b32 v6, 1, v6
    v_xor_b32 v4, v4, v6
    v_bfe_u32 v6, v5, 1, 1
    v_lshlrev_b32 v6, 2, v6
    v_xor_b32 v4, v4, v6
    v_bfe_u32 v6, v5, 3, 1
    v_lshlrev_b32 v6, 3, v6
    v_xor_b32 v4, v4, v6
    v_lshlrev_b32 v4, 4, v4
    v_add_u32 v4, s74, v4
    v_mad_u32_u24 v185, v5, s71, v4
    v_add_u32 v4, s72, v1
    v_add_u32 v4, 128, v4
    v_mul_u32_u24 v5, s73, v4
    v_lshrrev_b32 v5, 16, v5
    v_mul_u32_u24 v6, 16, v5
    v_sub_u32 v4, v4, v6
    v_bfe_u32 v6, v5, 0, 1
    v_lshlrev_b32 v6, 1, v6
    v_xor_b32 v4, v4, v6
    v_bfe_u32 v6, v5, 1, 1
    v_lshlrev_b32 v6, 2, v6
    v_xor_b32 v4, v4, v6
    v_bfe_u32 v6, v5, 3, 1
    v_lshlrev_b32 v6, 3, v6
    v_xor_b32 v4, v4, v6
    v_lshlrev_b32 v4, 4, v4
    v_add_u32 v4, s74, v4
    v_mad_u32_u24 v186, v5, s71, v4
    v_add_u32 v4, s72, v1
    v_add_u32 v4, 192, v4
    v_mul_u32_u24 v5, s73, v4
    v_lshrrev_b32 v5, 16, v5
    v_mul_u32_u24 v6, 16, v5
    v_sub_u32 v4, v4, v6
    v_bfe_u32 v6, v5, 0, 1
    v_lshlrev_b32 v6, 1, v6
    v_xor_b32 v4, v4, v6
    v_bfe_u32 v6, v5, 1, 1
    v_lshlrev_b32 v6, 2, v6
    v_xor_b32 v4, v4, v6
    v_bfe_u32 v6, v5, 3, 1
    v_lshlrev_b32 v6, 3, v6
    v_xor_b32 v4, v4, v6
    v_lshlrev_b32 v4, 4, v4
    v_add_u32 v4, s74, v4
    v_mad_u32_u24 v187, v5, s71, v4
    s_mul_i32 s75, s79, 4096
    s_mul_i32 s76, s79, 4096
    s_add_u32 s76, s76, 16384
    s_mov_b32 s67, 0
    s_mov_b32 s68, 0
    s_mov_b32 s40, s16
    s_mov_b32 s41, s17
    s_mov_b32 s42, 2621440
    s_mov_b32 s43, 0x00020000
    s_mov_b32 s44, s18
    s_mov_b32 s45, s19
    s_mov_b32 s46, 2457600
    s_mov_b32 s47, 0x00020000
    s_waitcnt vmcnt(10)
    s_barrier
    s_waitcnt vmcnt(5)
    s_barrier
    s_waitcnt vmcnt(0)
    s_barrier
    s_waitcnt vmcnt(0)
    s_barrier
    s_mov_b32 s70, 2
Liss_21:
    s_add_u32 m0, s75, 0
    s_nop 0
    buffer_load_dwordx4 v176, s[40:43], s67 offen lds
    s_add_u32 m0, s75, 1024
    s_nop 0
    buffer_load_dwordx4 v177, s[40:43], s67 offen lds
    s_add_u32 m0, s75, 2048
    s_nop 0
    buffer_load_dwordx4 v178, s[40:43], s67 offen lds
    s_add_u32 m0, s75, 3072
    s_nop 0
    buffer_load_dwordx4 v179, s[40:43], s67 offen lds
    s_add_u32 m0, s76, 0
    s_nop 0
    buffer_load_dwordx4 v184, s[44:47], s68 offen lds
    s_add_u32 m0, s76, 1024
    s_nop 0
    buffer_load_dwordx4 v185, s[44:47], s68 offen lds
    s_add_u32 m0, s76, 2048
    s_nop 0
    buffer_load_dwordx4 v186, s[44:47], s68 offen lds
    s_add_u32 m0, s76, 3072
    s_nop 0
    buffer_load_dwordx4 v187, s[44:47], s68 offen lds
    s_add_u32 s67, s67, 128
    s_add_u32 s68, s68, 245760
    s_add_u32 s75, s75, 32768
    s_add_u32 s76, s76, 32768
    s_cmp_ge_u32 s75, 163840
    s_cselect_b32 s69, 163840, 0
    s_sub_u32 s75, s75, s69
    s_sub_u32 s76, s76, s69
    s_sub_u32 s70, s70, 1
    s_cmp_lg_u32 s70, 0
    s_cbranch_scc1 Liss_21
    s_mov_b32 s92, s36
    s_mov_b32 s93, s37
    s_mov_b32 s94, 256
    s_mov_b32 s95, 0x00020000
    v_mov_b32 v4, 0
    s_mov_b32 s70, 0
Ltag_22:
    buffer_load_dwordx2 v[6:7], v4, s[92:95], 0 offen sc1
    s_waitcnt vmcnt(0)
    v_readfirstlane_b32 s98, v6
    v_readfirstlane_b32 s99, v7
    s_add_u32 s70, s70, 1
    s_cmp_ge_u32 s70, 0x100000
    s_cbranch_scc1 Ltq_23
    s_cmp_eq_u32 s98, 0
    s_cbranch_scc1 Ltag_22
Ltq_23:
    s_mov_b32 s7, s15
    s_mov_b32 s15, s14
    s_waitcnt vmcnt(0)
    s_barrier
    s_mov_b32 s70, 3
Liss_24:
    s_add_u32 m0, s75, 0
    s_nop 0
    buffer_load_dwordx4 v176, s[40:43], s67 offen lds
    s_add_u32 m0, s75, 1024
    s_nop 0
    buffer_load_dwordx4 v177, s[40:43], s67 offen lds
    s_add_u32 m0, s75, 2048
    s_nop 0
    buffer_load_dwordx4 v178, s[40:43], s67 offen lds
    s_add_u32 m0, s75, 3072
    s_nop 0
    buffer_load_dwordx4 v179, s[40:43], s67 offen lds
    s_add_u32 m0, s76, 0
    s_nop 0
    buffer_load_dwordx4 v184, s[44:47], s68 offen lds
    s_add_u32 m0, s76, 1024
    s_nop 0
    buffer_load_dwordx4 v185, s[44:47], s68 offen lds
    s_add_u32 m0, s76, 2048
    s_nop 0
    buffer_load_dwordx4 v186, s[44:47], s68 offen lds
    s_add_u32 m0, s76, 3072
    s_nop 0
    buffer_load_dwordx4 v187, s[44:47], s68 offen lds
    s_add_u32 s67, s67, 128
    s_add_u32 s68, s68, 245760
    s_add_u32 s75, s75, 32768
    s_add_u32 s76, s76, 32768
    s_cmp_ge_u32 s75, 163840
    s_cselect_b32 s69, 163840, 0
    s_sub_u32 s75, s75, s69
    s_sub_u32 s76, s76, s69
    s_sub_u32 s70, s70, 1
    s_cmp_lg_u32 s70, 0
    s_cbranch_scc1 Liss_24
    s_mov_b32 s70, 5
Lldm_25:
    s_waitcnt vmcnt(16)
    s_barrier
    s_cmp_lg_u32 s70, 3
    s_cbranch_scc1 Lnp_26
    s_cmp_lg_u32 s66, 4
    s_cbranch_scc1 Lfl_27
    s_add_u32 s92, s38, 31457280
    s_addc_u32 s93, s39, 0
    s_mov_b32 s94, 20480
    s_mov_b32 s95, 0x00020000
    s_lshl_b32 s71, s7, 3
    s_and_b32 s72, s7, 7
    s_lshl_b32 s72, s72, 5
    s_bfe_u32 s73, s7, 0x50003
    s_add_u32 s72, s72, s73
    s_and_b32 s73, s7, 0xffffff00
    s_add_u32 s72, s72, s73
    s_add_u32 s72, s72, 1280
    s_lshl_b32 s72, s72, 3
    s_sub_u32 s72, s72, s71
    v_mul_u32_u24 v4, s72, v1
    v_add_u32 v4, s71, v4
    v_mov_b32 v6, s98
    v_mov_b32 v7, s99
    s_mov_b64 exec, 3
    buffer_store_dwordx2 v[6:7], v4, s[92:95], 0 offen sc1
    s_mov_b64 exec, -1
Lfl_27:
Lnp_26:
    s_add_u32 m0, s75, 0
    s_nop 0
    buffer_load_dwordx4 v176, s[40:43], s67 offen lds
    s_add_u32 m0, s75, 1024
    s_nop 0
    buffer_load_dwordx4 v177, s[40:43], s67 offen lds
    s_add_u32 m0, s75, 2048
    s_nop 0
    buffer_load_dwordx4 v178, s[40:43], s67 offen lds
    s_add_u32 m0, s75, 3072
    s_nop 0
    buffer_load_dwordx4 v179, s[40:43], s67 offen lds
    s_add_u32 m0, s76, 0
    s_nop 0
    buffer_load_dwordx4 v184, s[44:47], s68 offen lds
    s_add_u32 m0, s76, 1024
    s_nop 0
    buffer_load_dwordx4 v185, s[44:47], s68 offen lds
    s_add_u32 m0, s76, 2048
    s_nop 0
    buffer_load_dwordx4 v186, s[44:47], s68 offen lds
    s_add_u32 m0, s76, 3072
    s_nop 0
    buffer_load_dwordx4 v187, s[44:47], s68 offen lds
    s_add_u32 s67, s67, 128
    s_add_u32 s68, s68, 245760
    s_add_u32 s75, s75, 32768
    s_add_u32 s76, s76, 32768
    s_cmp_ge_u32 s75, 163840
    s_cselect_b32 s69, 163840, 0
    s_sub_u32 s75, s75, s69
    s_sub_u32 s76, s76, s69
    s_sub_u32 s70, s70, 1
    s_cmp_lg_u32 s70, 0
    s_cbranch_scc1 Lldm_25
    s_lshr_b32 s5, s96, 1
    s_and_b32 s3, s96, 1
    s_and_b32 s6, s97, 7
    s_lshl_b32 s5, s5, 3
    s_add_u32 s77, s5, s6
    s_lshr_b32 s4, s97, 3
    s_lshl_b32 s3, s3, 2
    s_add_u32 s78, s3, s4
    s_lshl_b32 s64, s77, 6
    s_mul_i32 s65, s78, 80
    s_lshl_b32 s14, s77, 3
    s_add_u32 s14, s14, s78
    s_add_u32 s14, s14, 512
    v_lshrrev_b32 v2, 3, v1
    v_and_b32 v3, 7, v1
    s_mul_i32 s72, s79, 16
    s_mov_b32 s73, 1280
    s_lshr_b32 s72, s64, 4
    s_mul_i32 s73, s79, 1
    s_add_u32 s72, s72, s73
    s_mul_i32 s72, s72, 20480
    v_lshl_add_u32 v4, v1, 4, s72
    v_add_u32 v176, 0, v4
    v_add_u32 v177, 1024, v4
    s_mul_i32 s72, s79, 3072
    v_lshl_add_u32 v4, v1, 4, s72
    v_bfrev_b32 v7, 1
    v_add_u32 v184, 0, v4
    v_cmp_gt_u32 vcc, 10240, v184
    s_nop 1
    v_cndmask_b32 v184, v7, v184, vcc
    v_add_u32 v185, 1024, v4
    v_cmp_gt_u32 vcc, 10240, v185
    s_nop 1
    v_cndmask_b32 v185, v7, v185, vcc
    v_add_u32 v186, 2048, v4
    v_cmp_gt_u32 vcc, 10240, v186
    s_nop 1
    v_cndmask_b32 v186, v7, v186, vcc
    s_mul_i32 s72, s79, 192
    s_lshl_b32 s74, s65, 1
    s_mov_b32 s73, 5462
    s_mov_b32 s71, 1280
    v_bfrev_b32 v7, 1
    s_mul_i32 s75, s79, 2048
    s_mul_i32 s76, s79, 3072
    s_add_u32 s76, s76, 8192
    s_mov_b32 s67, 0
    s_mul_i32 s68, s78, 102400
    s_add_u32 s40, s38, 8392704
    s_addc_u32 s41, s39, 0
    s_mov_b32 s42, 2621440
    s_mov_b32 s43, 0x00020000
    s_add_u32 s44, s38, 33554432
    s_addc_u32 s45, s39, 0
    s_mov_b32 s46, 819200
    s_mov_b32 s47, 0x00020000
    s_cmp_lg_u32 s66, 4
    s_cbranch_scc1 Lpi_28
    v_lshrrev_b32 v4, 3, v1
    v_min_u32 v4, 2, v4
    s_sub_u32 s71, s77, 1
    v_add_u32 v4, s71, v4
    v_max_i32 v4, 0, v4
    v_min_i32 v4, 31, v4
    v_and_b32 v5, 7, v1
    v_lshl_add_u32 v4, v4, 3, v5
    v_and_b32 v5, 31, v1
    s_lshl_b32 s71, s78, 5
    s_add_u32 s71, s71, 1280
    v_add_u32 v5, s71, v5
    v_cmp_gt_u32 vcc, 32, v1
    s_nop 1
    v_cndmask_b32 v4, v5, v4, vcc
    v_lshlrev_b32 v14, 3, v4
    s_add_u32 s92, s38, 31457280
    s_addc_u32 s93, s39, 0
    s_mov_b32 s94, 20480
    s_mov_b32 s95, 0x00020000
    buffer_load_dwordx2 v[10:11], v14, s[92:95], 0 offen sc1
Lpi_28:
    s_waitcnt vmcnt(16)
    s_barrier
    s_waitcnt vmcnt(8)
    s_barrier
    s_waitcnt vmcnt(0)
    s_barrier
    s_waitcnt vmcnt(0)
    s_barrier
    s_xor_b32 s71, s98, 48
    v_mov_b32 v4, 86016
    s_mov_b32 s70, 0
    s_cmp_lg_u32 s66, 4
    s_cbranch_scc1 Lpo_32
    s_branch Lpc_31
Lpoll_29:
    buffer_load_dwordx2 v[10:11], v14, s[92:95], 0 offen sc1
    s_add_u32 s70, s70, 1
    s_cmp_ge_u32 s70, 0x100000
    s_cbranch_scc1 Lpx_30
Lpc_31:
    s_waitcnt vmcnt(0)
    v_cmp_ne_u32 vcc, s98, v10
    v_cmp_ne_u32 s[80:81], s99, v11
    s_or_b64 vcc, vcc, s[80:81]
    s_cbranch_scc1 Lpoll_29
Lpx_30:
    v_mov_b32 v6, s71
    v_mov_b32 v7, s99
    ds_write_b64 v4, v[6:7]
    s_waitcnt lgkmcnt(0)
    s_branch Lpd_33
Lpo_32:
    ds_read_b64 v[6:7], v4
    s_add_u32 s70, s70, 1
    s_cmp_ge_u32 s70, 0x1000000
    s_cbranch_scc1 Lpd_33
    s_waitcnt lgkmcnt(0)
    v_cmp_ne_u32 vcc, s71, v6
    v_cmp_ne_u32 s[80:81], s99, v7
    s_or_b64 vcc, vcc, s[80:81]
    s_cbranch_scc1 Lpo_32
Lpd_33:
    s_mov_b32 s70, 4
Liss_34:
    s_add_u32 m0, s75, 0
    s_nop 0
    buffer_load_dwordx4 v176, s[40:43], s67 offen sc1 lds
    s_add_u32 m0, s75, 1024
    s_nop 0
    buffer_load_dwordx4 v177, s[40:43], s67 offen sc1 lds
    s_add_u32 m0, s76, 0
    s_nop 0
    buffer_load_dwordx4 v184, s[44:47], s68 offen sc1 lds
    s_add_u32 m0, s76, 1024
    s_nop 0
    buffer_load_dwordx4 v185, s[44:47], s68 offen sc1 lds
    s_add_u32 m0, s76, 2048
    s_nop 0
    buffer_load_dwordx4 v186, s[44:47], s68 offen sc1 lds
    s_add_u32 s67, s67, 2048
    s_add_u32 s68, s68, 10240
    s_add_u32 s75, s75, 20480
    s_add_u32 s76, s76, 20480
    s_cmp_ge_u32 s75, 102400
    s_cselect_b32 s69, 102400, 0
    s_sub_u32 s75, s75, s69
    s_sub_u32 s76, s76, s69
    s_sub_u32 s70, s70, 1
    s_cmp_lg_u32 s70, 0
    s_cbranch_scc1 Liss_34
    s_mov_b32 s7, s15
    s_mov_b32 s15, s14
    s_waitcnt vmcnt(10)
    s_barrier
    s_add_u32 m0, s75, 0
    s_nop 0
    buffer_load_dwordx4 v176, s[40:43], s67 offen sc1 lds
    s_add_u32 m0, s75, 1024
    s_nop 0
    buffer_load_dwordx4 v177, s[40:43], s67 offen sc1 lds
    s_add_u32 m0, s76, 0
    s_nop 0
    buffer_load_dwordx4 v184, s[44:47], s68 offen sc1 lds
    s_add_u32 m0, s76, 1024
    s_nop 0
    buffer_load_dwordx4 v185, s[44:47], s68 offen sc1 lds
    s_add_u32 m0, s76, 2048
    s_nop 0
    buffer_load_dwordx4 v186, s[44:47], s68 offen sc1 lds
    s_add_u32 s67, s67, 2048
    s_add_u32 s68, s68, 10240
    s_add_u32 s75, s75, 20480
    s_add_u32 s76, s76, 20480
    s_cmp_ge_u32 s75, 102400
    s_cselect_b32 s69, 102400, 0
    s_sub_u32 s75, s75, s69
    s_sub_u32 s76, s76, s69
    s_mov_b32 s70, 5
Lldm_35:
    s_waitcnt vmcnt(10)
    s_barrier
    s_cmp_lg_u32 s70, 3
    s_cbranch_scc1 Lnp_36
    s_cmp_lg_u32 s66, 4
    s_cbranch_scc1 Lfl_37
    s_add_u32 s92, s38, 31457280
    s_addc_u32 s93, s39, 0
    s_mov_b32 s94, 20480
    s_mov_b32 s95, 0x00020000
    s_lshl_b32 s71, s7, 3
    s_and_b32 s72, s7, 7
    s_lshl_b32 s72, s72, 5
    s_bfe_u32 s73, s7, 0x50003
    s_add_u32 s72, s72, s73
    s_and_b32 s73, s7, 0xffffff00
    s_add_u32 s72, s72, s73
    s_add_u32 s72, s72, 1280
    s_lshl_b32 s72, s72, 3
    s_sub_u32 s72, s72, s71
    v_mul_u32_u24 v4, s72, v1
    v_add_u32 v4, s71, v4
    v_mov_b32 v6, s98
    v_mov_b32 v7, s99
    s_mov_b64 exec, 3
    buffer_store_dwordx2 v[6:7], v4, s[92:95], 0 offen sc1
    s_mov_b64 exec, -1
Lfl_37:
Lnp_36:
    s_add_u32 m0, s75, 0
    s_nop 0
    buffer_load_dwordx4 v176, s[40:43], s67 offen sc1 lds
    s_add_u32 m0, s75, 1024
    s_nop 0
    buffer_load_dwordx4 v177, s[40:43], s67 offen sc1 lds
    s_add_u32 m0, s76, 0
    s_nop 0
    buffer_load_dwordx4 v184, s[44:47], s68 offen sc1 lds
    s_add_u32 m0, s76, 1024
    s_nop 0
    buffer_load_dwordx4 v185, s[44:47], s68 offen sc1 lds
    s_add_u32 m0, s76, 2048
    s_nop 0
    buffer_load_dwordx4 v186, s[44:47], s68 offen sc1 lds
    s_add_u32 s67, s67, 2048
    s_add_u32 s68, s68, 10240
    s_add_u32 s75, s75, 20480
    s_add_u32 s76, s76, 20480
    s_cmp_ge_u32 s75, 102400
    s_cselect_b32 s69, 102400, 0
    s_sub_u32 s75, s75, s69
    s_sub_u32 s76, s76, s69
    s_sub_u32 s70, s70, 1
    s_cmp_lg_u32 s70, 0
    s_cbranch_scc1 Lldm_35
    s_lshr_b32 s5, s96, 1
    s_and_b32 s3, s96, 1
    s_and_b32 s6, s97, 7
    s_lshl_b32 s5, s5, 3
    s_add_u32 s77, s5, s6
    s_lshr_b32 s4, s97, 3
    s_lshl_b32 s3, s3, 2
    s_add_u32 s78, s3, s4
    s_lshl_b32 s64, s77, 6
    s_mul_i32 s65, s78, 80
    s_lshl_b32 s14, s77, 3
    s_add_u32 s14, s14, s78
    s_lshl_b32 s71, s78, 3
    s_add_u32 s64, s64, s71
    s_add_u32 s14, s14, 768
    s_sub_u32 s71, s64, 14
    s_mul_i32 s71, s71, 3840
    s_lshl_b32 s75, s79, 10
    s_add_u32 s71, s71, s75
    v_lshl_add_u32 v176, v1, 4, s71
    v_bfrev_b32 v177, 1
    s_mov_b32 s40, s38
    s_mov_b32 s41, s39
    s_mov_b32 s42, 7864320
    s_mov_b32 s43, 0x00020000
    s_cmp_lg_u32 s66, 4
    s_cbranch_scc1 Lpi_38
    s_sub_u32 s71, s64, 14
    s_max_i32 s71, s71, 0
    s_lshr_b32 s71, s71, 7
    s_lshr_b32 s72, s64, 7
    s_sub_u32 s72, s72, s71
    v_bfe_u32 v4, v1, 4, 1
    v_mul_u32_u24 v4, s72, v4
    v_add_u32 v4, s71, v4
    v_and_b32 v5, 15, v1
    v_lshl_add_u32 v4, v4, 4, v5
    v_add_u32 v4, 0x100, v4
    v_lshlrev_b32 v14, 3, v4
    s_add_u32 s92, s38, 31457280
    s_addc_u32 s93, s39, 0
    s_mov_b32 s94, 20480
    s_mov_b32 s95, 0x00020000
    buffer_load_dwordx2 v[10:11], v14, s[92:95], 0 offen sc1
Lpi_38:
    s_waitcnt vmcnt(10)
    s_barrier
    s_waitcnt vmcnt(5)
    s_barrier
    s_waitcnt vmcnt(0)
    s_barrier
    s_waitcnt vmcnt(0)
    s_barrier
    s_xor_b32 s71, s98, 64
    v_mov_b32 v4, 122880
    s_mov_b32 s70, 0
    s_cmp_lg_u32 s66, 4
    s_cbranch_scc1 Lpo_42
    s_branch Lpc_41
Lpoll_39:
    buffer_load_dwordx2 v[10:11], v14, s[92:95], 0 offen sc1
    s_add_u32 s70, s70, 1
    s_cmp_ge_u32 s70, 0x100000
    s_cbranch_scc1 Lpx_40
Lpc_41:
    s_waitcnt vmcnt(0)
    v_cmp_ne_u32 vcc, s98, v10
    v_cmp_ne_u32 s[80:81], s99, v11
    s_or_b64 vcc, vcc, s[80:81]
    s_cbranch_scc1 Lpoll_39
Lpx_40:
    v_mov_b32 v6, s71
    v_mov_b32 v7, s99
    ds_write_b64 v4, v[6:7]
    s_waitcnt lgkmcnt(0)
    s_branch Lpd_43
Lpo_42:
    ds_read_b64 v[6:7], v4
    s_add_u32 s70, s70, 1
    s_cmp_ge_u32 s70, 0x1000000
    s_cbranch_scc1 Lpd_43
    s_waitcnt lgkmcnt(0)
    v_cmp_ne_u32 vcc, s71, v6
    v_cmp_ne_u32 s[80:81], s99, v7
    s_or_b64 vcc, vcc, s[80:81]
    s_cbranch_scc1 Lpo_42
Lpd_43:
    s_mov_b32 s70, 20
Lai_44:
    v_cmp_gt_i32 vcc, 0, v176
    s_mov_b32 m0, s75
    s_add_u32 s75, s75, 0x1000
    v_cndmask_b32 v3, v176, v177, vcc
    buffer_load_dwordx4 v3, s[40:43], 0 offen sc1 lds
    v_add_u32 v176, 0x1000, v176
    s_sub_u32 s70, s70, 1
    s_cmp_lg_u32 s70, 0
    s_cbranch_scc1 Lai_44
    s_barrier
    s_mov_b32 s70, 1
Lai_45:
    v_cmp_gt_i32 vcc, 0, v176
    s_mov_b32 m0, s75
    s_add_u32 s75, s75, 0x1000
    v_cndmask_b32 v3, v176, v177, vcc
    buffer_load_dwordx4 v3, s[40:43], 0 offen sc1 lds
    v_add_u32 v176, 0x1000, v176
    s_sub_u32 s70, s70, 1
    s_cmp_lg_u32 s70, 0
    s_cbranch_scc1 Lai_45
    s_mov_b32 s7, s15
    s_mov_b32 s15, s14
    s_lshr_b32 s5, s96, 1
    s_and_b32 s3, s96, 1
    s_and_b32 s6, s97, 3
    s_lshl_b32 s5, s5, 2
    s_add_u32 s77, s5, s6
    s_lshr_b32 s4, s97, 2
    s_lshl_b32 s3, s3, 3
    s_add_u32 s78, s3, s4
    s_lshl_b32 s64, s77, 7
    s_mul_i32 s65, s78, 27
    s_lshr_b32 s65, s65, 1
    s_lshl_b32 s65, s65, 3
    s_lshl_b32 s14, s77, 4
    s_add_u32 s14, s14, s78
    s_add_u32 s14, s14, 1024
    v_lshrrev_b32 v2, 3, v1
    v_and_b32 v3, 7, v1
    s_mul_i32 s72, s79, 32
    s_mov_b32 s73, 1280
    s_lshr_b32 s72, s64, 4
    s_mul_i32 s73, s79, 2
    s_add_u32 s72, s72, s73
    s_mul_i32 s72, s72, 20480
    v_lshl_add_u32 v4, v1, 4, s72
    v_add_u32 v176, 0, v4
    v_add_u32 v177, 1024, v4
    v_add_u32 v178, 20480, v4
    v_add_u32 v179, 21504, v4
    s_mul_i32 s72, s79, 4096
    v_lshl_add_u32 v4, v1, 4, s72
    v_bfrev_b32 v7, 1
    v_add_u32 v184, 0, v4
    v_cmp_gt_u32 vcc, 14336, v184
    s_nop 1
    v_cndmask_b32 v184, v7, v184, vcc
    v_add_u32 v185, 1024, v4
    v_cmp_gt_u32 vcc, 14336, v185
    s_nop 1
    v_cndmask_b32 v185, v7, v185, vcc
    v_add_u32 v186, 2048, v4
    v_cmp_gt_u32 vcc, 14336, v186
    s_nop 1
    v_cndmask_b32 v186, v7, v186, vcc
    v_add_u32 v187, 3072, v4
    v_cmp_gt_u32 vcc, 14336, v187
    s_nop 1
    v_cndmask_b32 v187, v7, v187, vcc
    s_mul_i32 s72, s79, 256
    s_lshl_b32 s74, s65, 1
    s_mov_b32 s73, 4096
    s_mov_b32 s71, 3456
    v_bfrev_b32 v7, 1
    s_mul_i32 s75, s79, 4096
    s_mul_i32 s76, s79, 4096
    s_add_u32 s76, s76, 114688
    s_add_u32 s75, s75, 98304
    s_mov_b32 s67, 0
    s_mul_i32 s68, s78, 143360
    s_add_u32 s40, s38, 14680064
    s_addc_u32 s41, s39, 0
    s_mov_b32 s42, 2621440
    s_mov_b32 s43, 0x00020000
    s_add_u32 s44, s38, 35651584
    s_addc_u32 s45, s39, 0
    s_mov_b32 s46, 2293760
    s_mov_b32 s47, 0x00020000
    s_waitcnt vmcnt(0)
    s_barrier
    s_cmp_lg_u32 s66, 4
    s_cbranch_scc1 Lfl_46
    s_add_u32 s92, s38, 31457280
    s_addc_u32 s93, s39, 0
    s_mov_b32 s94, 20480
    s_mov_b32 s95, 0x00020000
    s_lshl_b32 s71, s7, 3
    s_and_b32 s72, s7, 7
    s_lshl_b32 s72, s72, 5
    s_bfe_u32 s73, s7, 0x50003
    s_add_u32 s72, s72, s73
    s_and_b32 s73, s7, 0xffffff00
    s_add_u32 s72, s72, s73
    s_add_u32 s72, s72, 1280
    s_lshl_b32 s72, s72, 3
    s_sub_u32 s72, s72, s71
    v_mul_u32_u24 v4, s72, v1
    v_add_u32 v4, s71, v4
    v_mov_b32 v6, s98
    v_mov_b32 v7, s99
    s_mov_b64 exec, 3
    buffer_store_dwordx2 v[6:7], v4, s[92:95], 0 offen sc1
    s_mov_b64 exec, -1
Lfl_46:
    s_cmp_lg_u32 s66, 4
    s_cbranch_scc1 Lpi_47
    s_lshl_b32 s71, s77, 4
    s_add_u32 s71, s71, 512
    v_and_b32 v4, 15, v1
    v_add_u32 v4, s71, v4
    v_and_b32 v5, 15, v1
    s_and_b32 s71, s78, 1
    s_lshr_b32 s72, s78, 1
    s_lshl_b32 s72, s72, 5
    s_add_u32 s71, s71, s72
    s_add_u32 s71, s71, 1792
    v_lshl_add_u32 v5, v5, 1, s71
    v_cmp_gt_u32 vcc, 32, v1
    s_nop 1
    v_cndmask_b32 v4, v5, v4, vcc
    v_lshlrev_b32 v14, 3, v4
    s_add_u32 s92, s38, 31457280
    s_addc_u32 s93, s39, 0
    s_mov_b32 s94, 20480
    s_mov_b32 s95, 0x00020000
    buffer_load_dwordx2 v[10:11], v14, s[92:95], 0 offen sc1
Lpi_47:
    s_xor_b32 s71, s98, 80
    v_mov_b32 v4, 97280
    s_mov_b32 s70, 0
    s_cmp_lg_u32 s66, 4
    s_cbranch_scc1 Lpo_51
    s_branch Lpc_50
Lpoll_48:
    buffer_load_dwordx2 v[10:11], v14, s[92:95], 0 offen sc1
    s_add_u32 s70, s70, 1
    s_cmp_ge_u32 s70, 0x100000
    s_cbranch_scc1 Lpx_49
Lpc_50:
    s_waitcnt vmcnt(0)
    v_cmp_ne_u32 vcc, s98, v10
    v_cmp_ne_u32 s[80:81], s99, v11
    s_or_b64 vcc, vcc, s[80:81]
    s_cbranch_scc1 Lpoll_48
Lpx_49:
    v_mov_b32 v6, s71
    v_mov_b32 v7, s99
    ds_write_b64 v4, v[6:7]
    s_waitcnt lgkmcnt(0)
    s_branch Lpd_52
Lpo_51:
    ds_read_b64 v[6:7], v4
    s_add_u32 s70, s70, 1
    s_cmp_ge_u32 s70, 0x1000000
    s_cbranch_scc1 Lpd_52
    s_waitcnt lgkmcnt(0)
    v_cmp_ne_u32 vcc, s71, v6
    v_cmp_ne_u32 s[80:81], s99, v7
    s_or_b64 vcc, vcc, s[80:81]
    s_cbranch_scc1 Lpo_51
Lpd_52:
    s_mov_b32 s70, 2
Liss_53:
    s_add_u32 m0, s75, 0
    s_nop 0
    buffer_load_dwordx4 v176, s[40:43], s67 offen sc1 lds
    s_add_u32 m0, s75, 1024
    s_nop 0
    buffer_load_dwordx4 v177, s[40:43], s67 offen sc1 lds
    s_add_u32 m0, s75, 2048
    s_nop 0
    buffer_load_dwordx4 v178, s[40:43], s67 offen sc1 lds
    s_add_u32 m0, s75, 3072
    s_nop 0
    buffer_load_dwordx4 v179, s[40:43], s67 offen sc1 lds
    s_add_u32 m0, s76, 0
    s_nop 0
    buffer_load_dwordx4 v184, s[44:47], s68 offen sc1 lds
    s_add_u32 m0, s76, 1024
    s_nop 0
    buffer_load_dwordx4 v185, s[44:47], s68 offen sc1 lds
    s_add_u32 m0, s76, 2048
    s_nop 0
    buffer_load_dwordx4 v186, s[44:47], s68 offen sc1 lds
    s_add_u32 m0, s76, 3072
    s_nop 0
    buffer_load_dwordx4 v187, s[44:47], s68 offen sc1 lds
    s_add_u32 s67, s67, 2048
    s_add_u32 s68, s68, 14336
    s_add_u32 s75, s75, 32768
    s_add_u32 s76, s76, 32768
    s_cmp_ge_u32 s75, 163840
    s_cselect_b32 s69, 163840, 0
    s_sub_u32 s75, s75, s69
    s_sub_u32 s76, s76, s69
    s_sub_u32 s70, s70, 1
    s_cmp_lg_u32 s70, 0
    s_cbranch_scc1 Liss_53
    s_barrier
    s_mov_b32 s7, s15
    s_mov_b32 s15, s14
    s_waitcnt vmcnt(0)
    s_barrier
    s_mov_b32 s70, 3
Liss_54:
    s_add_u32 m0, s75, 0
    s_nop 0
    buffer_load_dwordx4 v176, s[40:43], s67 offen sc1 lds
    s_add_u32 m0, s75, 1024
    s_nop 0
    buffer_load_dwordx4 v177, s[40:43], s67 offen sc1 lds
    s_add_u32 m0, s75, 2048
    s_nop 0
    buffer_load_dwordx4 v178, s[40:43], s67 offen sc1 lds
    s_add_u32 m0, s75, 3072
    s_nop 0
    buffer_load_dwordx4 v179, s[40:43], s67 offen sc1 lds
    s_add_u32 m0, s76, 0
    s_nop 0
    buffer_load_dwordx4 v184, s[44:47], s68 offen sc1 lds
    s_add_u32 m0, s76, 1024
    s_nop 0
    buffer_load_dwordx4 v185, s[44:47], s68 offen sc1 lds
    s_add_u32 m0, s76, 2048
    s_nop 0
    buffer_load_dwordx4 v186, s[44:47], s68 offen sc1 lds
    s_add_u32 m0, s76, 3072
    s_nop 0
    buffer_load_dwordx4 v187, s[44:47], s68 offen sc1 lds
    s_add_u32 s67, s67, 2048
    s_add_u32 s68, s68, 14336
    s_add_u32 s75, s75, 32768
    s_add_u32 s76, s76, 32768
    s_cmp_ge_u32 s75, 163840
    s_cselect_b32 s69, 163840, 0
    s_sub_u32 s75, s75, s69
    s_sub_u32 s76, s76, s69
    s_sub_u32 s70, s70, 1
    s_cmp_lg_u32 s70, 0
    s_cbranch_scc1 Liss_54
    s_mov_b32 s70, 5
Lldm_55:
    s_waitcnt vmcnt(16)
    s_barrier
    s_cmp_lg_u32 s70, 3
    s_cbranch_scc1 Lnp_56
    s_cmp_lg_u32 s66, 4
    s_cbranch_scc1 Lfl_57
    s_add_u32 s92, s38, 31457280
    s_addc_u32 s93, s39, 0
    s_mov_b32 s94, 20480
    s_mov_b32 s95, 0x00020000
    s_lshl_b32 s71, s7, 3
    s_and_b32 s72, s7, 7
    s_lshl_b32 s72, s72, 5
    s_bfe_u32 s73, s7, 0x50003
    s_add_u32 s72, s72, s73
    s_and_b32 s73, s7, 0xffffff00
    s_add_u32 s72, s72, s73
    s_add_u32 s72, s72, 1280
    s_lshl_b32 s72, s72, 3
    s_sub_u32 s72, s72, s71
    v_mul_u32_u24 v4, s72, v1
    v_add_u32 v4, s71, v4
    v_mov_b32 v6, s98
    v_mov_b32 v7, s99
    s_mov_b64 exec, 3
    buffer_store_dwordx2 v[6:7], v4, s[92:95], 0 offen sc1
    s_mov_b64 exec, -1
Lfl_57:
Lnp_56:
    s_add_u32 m0, s75, 0
    s_nop 0
    buffer_load_dwordx4 v176, s[40:43], s67 offen sc1 lds
    s_add_u32 m0, s75, 1024
    s_nop 0
    buffer_load_dwordx4 v177, s[40:43], s67 offen sc1 lds
    s_add_u32 m0, s75, 2048
    s_nop 0
    buffer_load_dwordx4 v178, s[40:43], s67 offen sc1 lds
    s_add_u32 m0, s75, 3072
    s_nop 0
    buffer_load_dwordx4 v179, s[40:43], s67 offen sc1 lds
    s_add_u32 m0, s76, 0
    s_nop 0
    buffer_load_dwordx4 v184, s[44:47], s68 offen sc1 lds
    s_add_u32 m0, s76, 1024
    s_nop 0
    buffer_load_dwordx4 v185, s[44:47], s68 offen sc1 lds
    s_add_u32 m0, s76, 2048
    s_nop 0
    buffer_load_dwordx4 v186, s[44:47], s68 offen sc1 lds
    s_add_u32 m0, s76, 3072
    s_nop 0
    buffer_load_dwordx4 v187, s[44:47], s68 offen sc1 lds
    s_add_u32 s67, s67, 2048
    s_add_u32 s68, s68, 14336
    s_add_u32 s75, s75, 32768
    s_add_u32 s76, s76, 32768
    s_cmp_ge_u32 s75, 163840
    s_cselect_b32 s69, 163840, 0
    s_sub_u32 s75, s75, s69
    s_sub_u32 s76, s76, s69
    s_sub_u32 s70, s70, 1
    s_cmp_lg_u32 s70, 0
    s_cbranch_scc1 Lldm_55
    s_lshr_b32 s5, s96, 1
    s_and_b32 s3, s96, 1
    s_and_b32 s6, s97, 7
    s_lshl_b32 s5, s5, 3
    s_add_u32 s77, s5, s6
    s_lshr_b32 s4, s97, 3
    s_lshl_b32 s3, s3, 2
    s_add_u32 s78, s3, s4
    s_lshl_b32 s64, s77, 6
    s_mul_i32 s65, s78, 80
    s_lshl_b32 s14, s77, 3
    s_add_u32 s14, s14, s78
    v_lshrrev_b32 v2, 3, v1
    v_and_b32 v3, 7, v1
    s_mul_i32 s72, s79, 16
    s_mov_b32 s73, 1280
    s_lshr_b32 s72, s64, 4
    s_mul_i32 s73, s79, 1
    s_add_u32 s72, s72, s73
    s_mul_i32 s72, s72, 20480
    v_lshl_add_u32 v4, v1, 4, s72
    v_add_u32 v176, 0, v4
    v_add_u32 v177, 1024, v4
    s_mul_i32 s72, s79, 3072
    v_lshl_add_u32 v4, v1, 4, s72
    v_bfrev_b32 v7, 1
    v_add_u32 v184, 0, v4
    v_cmp_gt_u32 vcc, 10240, v184
    s_nop 1
    v_cndmask_b32 v184, v7, v184, vcc
    v_add_u32 v185, 1024, v4
    v_cmp_gt_u32 vcc, 10240, v185
    s_nop 1
    v_cndmask_b32 v185, v7, v185, vcc
    v_add_u32 v186, 2048, v4
    v_cmp_gt_u32 vcc, 10240, v186
    s_nop 1
    v_cndmask_b32 v186, v7, v186, vcc
    s_mul_i32 s72, s79, 192
    s_lshl_b32 s74, s65, 1
    s_mov_b32 s73, 5462
    s_mov_b32 s71, 1280
    v_bfrev_b32 v7, 1
    s_mul_i32 s75, s79, 2048
    s_mul_i32 s76, s79, 3072
    s_add_u32 s76, s76, 8192
    s_mov_b32 s67, 0
    s_mul_i32 s68, s78, 102400
    s_add_u32 s40, s38, 11534336
    s_addc_u32 s41, s39, 0
    s_mov_b32 s42, 2621440
    s_mov_b32 s43, 0x00020000
    s_add_u32 s44, s38, 34603008
    s_addc_u32 s45, s39, 0
    s_mov_b32 s46, 819200
    s_mov_b32 s47, 0x00020000
    s_cmp_lg_u32 s66, 4
    s_cbranch_scc1 Lpi_58
    s_lshl_b32 s71, s77, 3
    s_add_u32 s71, s71, 768
    v_and_b32 v4, 7, v1
    v_add_u32 v4, s71, v4
    v_and_b32 v5, 31, v1
    s_lshl_b32 s71, s78, 5
    s_add_u32 s71, s71, 2048
    v_add_u32 v5, s71, v5
    v_cmp_gt_u32 vcc, 32, v1
    s_nop 1
    v_cndmask_b32 v4, v5, v4, vcc
    v_lshlrev_b32 v14, 3, v4
    s_add_u32 s92, s38, 31457280
    s_addc_u32 s93, s39, 0
    s_mov_b32 s94, 20480
    s_mov_b32 s95, 0x00020000
    buffer_load_dwordx2 v[10:11], v14, s[92:95], 0 offen sc1
Lpi_58:
    s_waitcnt vmcnt(16)
    s_barrier
    s_waitcnt vmcnt(8)
    s_barrier
    s_waitcnt vmcnt(0)
    s_barrier
    s_waitcnt vmcnt(0)
    s_barrier
    s_barrier
    s_xor_b32 s71, s98, 96
    v_mov_b32 v4, 63488
    s_mov_b32 s70, 0
    s_cmp_lg_u32 s66, 4
    s_cbranch_scc1 Lpo_62
    s_branch Lpc_61
Lpoll_59:
    buffer_load_dwordx2 v[10:11], v14, s[92:95], 0 offen sc1
    s_add_u32 s70, s70, 1
    s_cmp_ge_u32 s70, 0x100000
    s_cbranch_scc1 Lpx_60
Lpc_61:
    s_waitcnt vmcnt(0)
    v_cmp_ne_u32 vcc, s98, v10
    v_cmp_ne_u32 s[80:81], s99, v11
    s_or_b64 vcc, vcc, s[80:81]
    s_cbranch_scc1 Lpoll_59
Lpx_60:
    v_mov_b32 v6, s71
    v_mov_b32 v7, s99
    ds_write_b64 v4, v[6:7]
    s_waitcnt lgkmcnt(0)
    s_branch Lpd_63
Lpo_62:
    ds_read_b64 v[6:7], v4
    s_add_u32 s70, s70, 1
    s_cmp_ge_u32 s70, 0x1000000
    s_cbranch_scc1 Lpd_63
    s_waitcnt lgkmcnt(0)
    v_cmp_ne_u32 vcc, s71, v6
    v_cmp_ne_u32 s[80:81], s99, v7
    s_or_b64 vcc, vcc, s[80:81]
    s_cbranch_scc1 Lpo_62
Lpd_63:
    s_mov_b32 s70, 3
Liss_64:
    s_add_u32 m0, s75, 0
    s_nop 0
    buffer_load_dwordx4 v176, s[40:43], s67 offen sc1 lds
    s_add_u32 m0, s75, 1024
    s_nop 0
    buffer_load_dwordx4 v177, s[40:43], s67 offen sc1 lds
    s_add_u32 m0, s76, 0
    s_nop 0
    buffer_load_dwordx4 v184, s[44:47], s68 offen sc1 lds
    s_add_u32 m0, s76, 1024
    s_nop 0
    buffer_load_dwordx4 v185, s[44:47], s68 offen sc1 lds
    s_add_u32 m0, s76, 2048
    s_nop 0
    buffer_load_dwordx4 v186, s[44:47], s68 offen sc1 lds
    s_add_u32 s67, s67, 2048
    s_add_u32 s68, s68, 10240
    s_add_u32 s75, s75, 20480
    s_add_u32 s76, s76, 20480
    s_cmp_ge_u32 s75, 102400
    s_cselect_b32 s69, 102400, 0
    s_sub_u32 s75, s75, s69
    s_sub_u32 s76, s76, s69
    s_sub_u32 s70, s70, 1
    s_cmp_lg_u32 s70, 0
    s_cbranch_scc1 Liss_64
    s_mov_b32 s7, s15
    s_mov_b32 s15, s14
    s_waitcnt vmcnt(5)
    s_barrier
    s_mov_b32 s70, 2
Liss_65:
    s_add_u32 m0, s75, 0
    s_nop 0
    buffer_load_dwordx4 v176, s[40:43], s67 offen sc1 lds
    s_add_u32 m0, s75, 1024
    s_nop 0
    buffer_load_dwordx4 v177, s[40:43], s67 offen sc1 lds
    s_add_u32 m0, s76, 0
    s_nop 0
    buffer_load_dwordx4 v184, s[44:47], s68 offen sc1 lds
    s_add_u32 m0, s76, 1024
    s_nop 0
    buffer_load_dwordx4 v185, s[44:47], s68 offen sc1 lds
    s_add_u32 m0, s76, 2048
    s_nop 0
    buffer_load_dwordx4 v186, s[44:47], s68 offen sc1 lds
    s_add_u32 s67, s67, 2048
    s_add_u32 s68, s68, 10240
    s_add_u32 s75, s75, 20480
    s_add_u32 s76, s76, 20480
    s_cmp_ge_u32 s75, 102400
    s_cselect_b32 s69, 102400, 0
    s_sub_u32 s75, s75, s69
    s_sub_u32 s76, s76, s69
    s_sub_u32 s70, s70, 1
    s_cmp_lg_u32 s70, 0
    s_cbranch_scc1 Liss_65
    s_mov_b32 s70, 5
Lldm_66:
    s_waitcnt vmcnt(10)
    s_barrier
    s_cmp_lg_u32 s70, 3
    s_cbranch_scc1 Lnp_67
    s_cmp_lg_u32 s66, 4
    s_cbranch_scc1 Lfl_68
    s_add_u32 s92, s38, 31457280
    s_addc_u32 s93, s39, 0
    s_mov_b32 s94, 20480
    s_mov_b32 s95, 0x00020000
    s_lshl_b32 s71, s7, 3
    s_and_b32 s72, s7, 7
    s_lshl_b32 s72, s72, 5
    s_bfe_u32 s73, s7, 0x50003
    s_add_u32 s72, s72, s73
    s_and_b32 s73, s7, 0xffffff00
    s_add_u32 s72, s72, s73
    s_add_u32 s72, s72, 1280
    s_lshl_b32 s72, s72, 3
    s_sub_u32 s72, s72, s71
    v_mul_u32_u24 v4, s72, v1
    v_add_u32 v4, s71, v4
    v_mov_b32 v6, s98
    v_mov_b32 v7, s99
    s_mov_b64 exec, 3
    buffer_store_dwordx2 v[6:7], v4, s[92:95], 0 offen sc1
    s_mov_b64 exec, -1
Lfl_68:
Lnp_67:
    s_add_u32 m0, s75, 0
    s_nop 0
    buffer_load_dwordx4 v176, s[40:43], s67 offen sc1 lds
    s_add_u32 m0, s75, 1024
    s_nop 0
    buffer_load_dwordx4 v177, s[40:43], s67 offen sc1 lds
    s_add_u32 m0, s76, 0
    s_nop 0
    buffer_load_dwordx4 v184, s[44:47], s68 offen sc1 lds
    s_add_u32 m0, s76, 1024
    s_nop 0
    buffer_load_dwordx4 v185, s[44:47], s68 offen sc1 lds
    s_add_u32 m0, s76, 2048
    s_nop 0
    buffer_load_dwordx4 v186, s[44:47], s68 offen sc1 lds
    s_add_u32 s67, s67, 2048
    s_add_u32 s68, s68, 10240
    s_add_u32 s75, s75, 20480
    s_add_u32 s76, s76, 20480
    s_cmp_ge_u32 s75, 102400
    s_cselect_b32 s69, 102400, 0
    s_sub_u32 s75, s75, s69
    s_sub_u32 s76, s76, s69
    s_sub_u32 s70, s70, 1
    s_cmp_lg_u32 s70, 0
    s_cbranch_scc1 Lldm_66
    s_lshr_b32 s5, s96, 1
    s_and_b32 s3, s96, 1
    s_and_b32 s6, s97, 7
    s_lshl_b32 s5, s5, 3
    s_add_u32 s77, s5, s6
    s_lshr_b32 s4, s97, 3
    s_lshl_b32 s3, s3, 2
    s_add_u32 s78, s3, s4
    s_lshl_b32 s64, s77, 6
    s_mul_i32 s65, s78, 80
    s_lshl_b32 s14, s77, 3
    s_add_u32 s14, s14, s78
    v_lshrrev_b32 v2, 3, v1
    v_and_b32 v3, 7, v1
    s_mul_i32 s72, s79, 16
    s_mov_b32 s73, 3456
    s_lshr_b32 s72, s64, 4
    s_mul_i32 s73, s79, 1
    s_add_u32 s72, s72, s73
    s_mul_i32 s72, s72, 55296
    v_lshl_add_u32 v4, v1, 4, s72
    v_add_u32 v176, 0, v4
    v_add_u32 v177, 1024, v4
    s_mul_i32 s72, s79, 3072
    v_lshl_add_u32 v4, v1, 4, s72
    v_bfrev_b32 v7, 1
    v_add_u32 v184, 0, v4
    v_cmp_gt_u32 vcc, 10240, v184
    s_nop 1
    v_cndmask_b32 v184, v7, v184, vcc
    v_add_u32 v185, 1024, v4
    v_cmp_gt_u32 vcc, 10240, v185
    s_nop 1
    v_cndmask_b32 v185, v7, v185, vcc
    v_add_u32 v186, 2048, v4
    v_cmp_gt_u32 vcc, 10240, v186
    s_nop 1
    v_cndmask_b32 v186, v7, v186, vcc
    s_mul_i32 s72, s79, 192
    s_lshl_b32 s74, s65, 1
    s_mov_b32 s73, 5462
    s_mov_b32 s71, 1280
    v_bfrev_b32 v7, 1
    s_mul_i32 s75, s79, 2048
    s_mul_i32 s76, s79, 3072
    s_add_u32 s76, s76, 8192
    s_mov_b32 s67, 0
    s_mul_i32 s68, s78, 276480
    s_add_u32 s40, s38, 20971520
    s_addc_u32 s41, s39, 0
    s_mov_b32 s42, 7077888
    s_mov_b32 s43, 0x00020000
    s_add_u32 s44, s38, 38797312
    s_addc_u32 s45, s39, 0
    s_mov_b32 s46, 2211840
    s_mov_b32 s47, 0x00020000
    s_cmp_lg_u32 s66, 4
    s_cbranch_scc1 Lpi_69
    s_lshr_b32 s71, s77, 1
    s_lshl_b32 s71, s71, 4
    s_add_u32 s71, s71, 1024
    v_and_b32 v4, 15, v1
    v_add_u32 v4, s71, v4
    v_lshlrev_b32 v14, 3, v4
    s_add_u32 s92, s38, 31457280
    s_addc_u32 s93, s39, 0
    s_mov_b32 s94, 20480
    s_mov_b32 s95, 0x00020000
    buffer_load_dwordx2 v[10:11], v14, s[92:95], 0 offen sc1
Lpi_69:
    s_waitcnt vmcnt(10)
    s_barrier
    s_waitcnt vmcnt(5)
    s_barrier
    s_waitcnt vmcnt(0)
    s_barrier
    s_waitcnt vmcnt(0)
    s_barrier
    s_xor_b32 s71, s98, 112
    v_mov_b32 v4, 122880
    s_mov_b32 s70, 0
    s_cmp_lg_u32 s66, 4
    s_cbranch_scc1 Lpo_73
    s_branch Lpc_72
Lpoll_70:
    buffer_load_dwordx2 v[10:11], v14, s[92:95], 0 offen sc1
    s_add_u32 s70, s70, 1
    s_cmp_ge_u32 s70, 0x100000
    s_cbranch_scc1 Lpx_71
Lpc_72:
    s_waitcnt vmcnt(0)
    v_cmp_ne_u32 vcc, s98, v10
    v_cmp_ne_u32 s[80:81], s99, v11
    s_or_b64 vcc, vcc, s[80:81]
    s_cbranch_scc1 Lpoll_70
Lpx_71:
    v_mov_b32 v6, s71
    v_mov_b32 v7, s99
    ds_write_b64 v4, v[6:7]
    s_waitcnt lgkmcnt(0)
    s_branch Lpd_74
Lpo_73:
    ds_read_b64 v[6:7], v4
    s_add_u32 s70, s70, 1
    s_cmp_ge_u32 s70, 0x1000000
    s_cbranch_scc1 Lpd_74
    s_waitcnt lgkmcnt(0)
    v_cmp_ne_u32 vcc, s71, v6
    v_cmp_ne_u32 s[80:81], s99, v7
    s_or_b64 vcc, vcc, s[80:81]
    s_cbranch_scc1 Lpo_73
Lpd_74:
    s_mov_b32 s70, 4
Liss_75:
    s_add_u32 m0, s75, 0
    s_nop 0
    buffer_load_dwordx4 v176, s[40:43], s67 offen sc1 lds
    s_add_u32 m0, s75, 1024
    s_nop 0
    buffer_load_dwordx4 v177, s[40:43], s67 offen sc1 lds
    s_add_u32 m0, s76, 0
    s_nop 0
    buffer_load_dwordx4 v184, s[44:47], s68 offen sc1 lds
    s_add_u32 m0, s76, 1024
    s_nop 0
    buffer_load_dwordx4 v185, s[44:47], s68 offen sc1 lds
    s_add_u32 m0, s76, 2048
    s_nop 0
    buffer_load_dwordx4 v186, s[44:47], s68 offen sc1 lds
    s_add_u32 s67, s67, 2048
    s_add_u32 s68, s68, 10240
    s_add_u32 s75, s75, 20480
    s_add_u32 s76, s76, 20480
    s_cmp_ge_u32 s75, 163840
    s_cselect_b32 s69, 163840, 0
    s_sub_u32 s75, s75, s69
    s_sub_u32 s76, s76, s69
    s_sub_u32 s70, s70, 1
    s_cmp_lg_u32 s70, 0
    s_cbranch_scc1 Liss_75
    s_mov_b32 s7, s15
    s_mov_b32 s15, s14
    s_waitcnt vmcnt(10)
    s_barrier
    s_mov_b32 s70, 4
Liss_76:
    s_add_u32 m0, s75, 0
    s_nop 0
    buffer_load_dwordx4 v176, s[40:43], s67 offen sc1 lds
    s_add_u32 m0, s75, 1024
    s_nop 0
    buffer_load_dwordx4 v177, s[40:43], s67 offen sc1 lds
    s_add_u32 m0, s76, 0
    s_nop 0
    buffer_load_dwordx4 v184, s[44:47], s68 offen sc1 lds
    s_add_u32 m0, s76, 1024
    s_nop 0
    buffer_load_dwordx4 v185, s[44:47], s68 offen sc1 lds
    s_add_u32 m0, s76, 2048
    s_nop 0
    buffer_load_dwordx4 v186, s[44:47], s68 offen sc1 lds
    s_add_u32 s67, s67, 2048
    s_add_u32 s68, s68, 10240
    s_add_u32 s75, s75, 20480
    s_add_u32 s76, s76, 20480
    s_cmp_ge_u32 s75, 163840
    s_cselect_b32 s69, 163840, 0
    s_sub_u32 s75, s75, s69
    s_sub_u32 s76, s76, s69
    s_sub_u32 s70, s70, 1
    s_cmp_lg_u32 s70, 0
    s_cbranch_scc1 Liss_76
    s_mov_b32 s70, 19
Lldm_77:
    s_waitcnt vmcnt(25)
    s_barrier
    s_add_u32 m0, s75, 0
    s_nop 0
    buffer_load_dwordx4 v176, s[40:43], s67 offen sc1 lds
    s_add_u32 m0, s75, 1024
    s_nop 0
    buffer_load_dwordx4 v177, s[40:43], s67 offen sc1 lds
    s_add_u32 m0, s76, 0
    s_nop 0
    buffer_load_dwordx4 v184, s[44:47], s68 offen sc1 lds
    s_add_u32 m0, s76, 1024
    s_nop 0
    buffer_load_dwordx4 v185, s[44:47], s68 offen sc1 lds
    s_add_u32 m0, s76, 2048
    s_nop 0
    buffer_load_dwordx4 v186, s[44:47], s68 offen sc1 lds
    s_add_u32 s67, s67, 2048
    s_add_u32 s68, s68, 10240
    s_add_u32 s75, s75, 20480
    s_add_u32 s76, s76, 20480
    s_cmp_ge_u32 s75, 163840
    s_cselect_b32 s69, 163840, 0
    s_sub_u32 s75, s75, s69
    s_sub_u32 s76, s76, s69
    s_sub_u32 s70, s70, 1
    s_cmp_lg_u32 s70, 0
    s_cbranch_scc1 Lldm_77
    s_waitcnt vmcnt(25)
    s_barrier
    s_waitcnt vmcnt(20)
    s_barrier
    s_waitcnt vmcnt(15)
    s_barrier
    s_waitcnt vmcnt(10)
    s_barrier
    s_waitcnt vmcnt(5)
    s_barrier
    s_waitcnt vmcnt(0)
    s_barrier
    s_waitcnt vmcnt(0)
    s_barrier
    s_endpgm
Lend:
    s_endpgm
.section .rodata,"a"
.p2align 6
.amdhsa_kernel gated_mix__sliding_local_dilated__mixer_s_mlp__prompt_kernel
  .amdhsa_next_free_vgpr 253
  .amdhsa_next_free_sgpr 102
  .amdhsa_accum_offset 256
  .amdhsa_group_segment_fixed_size 0
  .amdhsa_kernarg_size 96
  .amdhsa_user_sgpr_count 2
  .amdhsa_user_sgpr_kernarg_segment_ptr 1
  .amdhsa_system_sgpr_workgroup_id_x 1
.end_amdhsa_kernel
```
